```python
import torch

def _softmax(x, axis=-1):
    return torch.softmax(x, dim=axis)
def _gelu(x):
    return torch.nn.functional.gelu(x, approximate="tanh")
def _silu(x):
    return torch.nn.functional.silu(x)
def _sigmoid(x):
    return torch.sigmoid(x)
def _layernorm(x, axis=-1, eps=1e-5):
    m = x.mean(dim=axis, keepdim=True)
    v = x.var(dim=axis, keepdim=True, unbiased=False)
    return (x - m) / torch.sqrt(v + eps)
def _scatter_add(tgt, idx, src, axis=0):
    return tgt.clone().index_add_(axis, idx, src)
def _segment_sum(src, seg, n):
    out = torch.zeros((n,) + src.shape[1:], dtype=src.dtype)
    return out.index_add_(0, seg, src)
def _pad(x, pw):
    flat = tuple(v for pair in reversed(pw) for v in pair)
    return torch.nn.functional.pad(x, flat)

kernel_name = 'sequential_preLN__gqa_block_cached__mixer_token_mlp__decode'

def setup_inputs():

    _w = (lambda a: (lambda t: t.to(torch.bfloat16) if t.is_floating_point() else t)(torch.as_tensor(a)))
    def _A_setup():
        B, Sq, D = 2, 1, 576
        Hq, Hkv, Sk, Dh = 32, 16, 32768, 128
        assert Hq % Hkv == 0, (Hq, Hkv)
        return {
            "x": _w((lambda *s: torch.randn(*s, dtype=torch.bfloat16) * 0.05)(B, Sq, D)),
            "k_cache": _w((lambda *s: torch.randn(*s, dtype=torch.bfloat16) * 3.2)(B, Hkv, Sk, Dh)),
            "v_cache": _w((lambda *s: torch.randn(*s, dtype=torch.bfloat16) * 0.8)(B, Hkv, Sk, Dh)),
            "wq": _w((lambda *s: torch.randn(*s, dtype=torch.bfloat16) * 3.2)(D, Hq * Dh) * (D ** -0.5)),
            "wo": _w((lambda *s: torch.randn(*s, dtype=torch.bfloat16) * 0.8)(Hq * Dh, D) * ((Hq * Dh) ** -0.5)),
        }
    _A_in = _A_setup()

    def _B_setup():
        B, S, D, F = 2, 1, 576, 4608
        return {
            "x": _w((lambda *s: torch.randn(*s, dtype=torch.bfloat16) * 0.05)(B, S, D)),
            "w1": _w((lambda *s: torch.randn(*s, dtype=torch.bfloat16) * 0.8)(S, F) * (S ** -0.5)),
            "b1": _w((lambda *s: torch.randn(*s, dtype=torch.bfloat16) * 0.8)(F) * 0.02),
            "w2": _w((lambda *s: torch.randn(*s, dtype=torch.bfloat16) * 0.8)(F, S) * (F ** -0.5)),
            "b2": _w((lambda *s: torch.randn(*s, dtype=torch.bfloat16) * 0.8)(S) * 0.02),
        }
    _B_in = _B_setup()

    return {
        "A_x": _A_in["x"],
        "A_k_cache": _A_in["k_cache"],
        "A_v_cache": _A_in["v_cache"],
        "A_wq": _A_in["wq"],
        "A_wo": _A_in["wo"],
        "B_x": _B_in["x"],
        "B_w1": _B_in["w1"],
        "B_b1": _B_in["b1"],
        "B_w2": _B_in["w2"],
        "B_b2": _B_in["b2"],
    }

def reference(A_x, A_k_cache, A_v_cache, A_wq, A_wo, B_x, B_w1, B_b1, B_w2, B_b2):
    def _A_ref(x, k_cache, v_cache, wq, wo):
        B, Sq, D = x.shape
        Hq, Dh = 32, 128
        Hkv = k_cache.shape[1]
        rep = Hq // Hkv
        q = (lambda x, *d: x.permute(*d))((x @ wq).reshape(B, Sq, Hq, Dh), 0, 2, 1, 3)
        k = (lambda x, n, axis: torch.repeat_interleave(x, n, dim=axis))(k_cache, rep, axis=1)
        v = (lambda x, n, axis: torch.repeat_interleave(x, n, dim=axis))(v_cache, rep, axis=1)
        scores = torch.einsum("bhqd,bhkd->bhqk", q, k) * (Dh ** -0.5)
        p = _softmax(scores, axis=-1)
        o = torch.einsum("bhqk,bhkd->bhqd", p, v)
        return (lambda x, *d: x.permute(*d))(o, 0, 2, 1, 3).reshape(B, Sq, Hq * Dh) @ wo

    def _B_ref(x, w1, b1, w2, b2):
        B, S, D = x.shape
        h = _layernorm(x, axis=-1)
        u = torch.einsum("bsd,sf->bdf", h, w1) + b1
        u = _gelu(u)
        y = torch.einsum("bdf,fs->bds", u, w2) + b2
        return (lambda x, *d: x.permute(*d))(y, 0, 2, 1)

    x = A_x
    h = x + _A_ref(_layernorm(x, axis=-1), A_k_cache, A_v_cache, A_wq, A_wo)
    h2 = h + _B_ref(_layernorm(h, axis=-1), B_w1, B_b1, B_w2, B_b2)
    return h2
```

```asm
; @launch grid=(256,1,1) block=(512,1,1) lds=99328
.amdgcn_target "amdgcn-amd-amdhsa--gfx950"
.text
.globl sequential_preLN__gqa_block_cached__mixer_token_mlp__decode_kernel
.p2align 8
.type sequential_preLN__gqa_block_cached__mixer_token_mlp__decode_kernel,@function
sequential_preLN__gqa_block_cached__mixer_token_mlp__decode_kernel:
    s_load_dwordx16 s[4:19], s[0:1], 0
    s_load_dwordx8 s[20:27], s[0:1], 64
    s_load_dwordx2 s[28:29], s[0:1], 96
    v_lshrrev_b32 v164, 6, v0
    v_and_b32 v1, 63, v0
    v_readfirstlane_b32 s3, v164
    s_cmp_ge_u32 s2, 256
    s_cbranch_scc1 L_end
    s_mov_b32 s30, 0
    s_bitcmp1_b32 s2, 0
    s_cselect_b32 s56, 0xa834000, 0
    s_xor_b32 s30, s30, s56
    s_bitcmp1_b32 s2, 1
    s_cselect_b32 s56, 0xe1f4000, 0
    s_xor_b32 s30, s30, s56
    s_bitcmp1_b32 s2, 2
    s_cselect_b32 s56, 0x3cf0000, 0
    s_xor_b32 s30, s30, s56
    s_bitcmp1_b32 s2, 3
    s_cselect_b32 s56, 0x2980000, 0
    s_xor_b32 s30, s30, s56
    s_bitcmp1_b32 s2, 4
    s_cselect_b32 s56, 0x2b9a000, 0
    s_xor_b32 s30, s30, s56
    s_bitcmp1_b32 s2, 5
    s_cselect_b32 s56, 0xe7f5000, 0
    s_xor_b32 s30, s30, s56
    s_bitcmp1_b32 s2, 6
    s_cselect_b32 s56, 0x5f88000, 0
    s_xor_b32 s30, s30, s56
    s_bitcmp1_b32 s2, 7
    s_cselect_b32 s56, 0xd330000, 0
    s_xor_b32 s30, s30, s56
    s_lshr_b32 s2, s30, 20
    s_and_b32 s30, s30, 0xff000
    v_and_b32 v165, 3, v0
    v_lshlrev_b32 v165, 4, v165
    v_bfe_u32 v166, v0, 2, 2
    v_lshl_add_u32 v165, v166, 8, v165
    v_bfe_u32 v166, v0, 4, 2
    v_lshl_add_u32 v2, v166, 6, v165
    v_lshlrev_b32 v3, 4, v1
    s_lshr_b32 s56, s2, 3
    s_lshl_b32 s56, s56, 23
    s_mov_b32 s34, 0x800000
    s_mov_b32 s35, 0x20000
    s_mov_b32 s38, 0x800000
    s_mov_b32 s39, 0x20000
    s_and_b32 s57, s2, 7
    s_lshl_b32 s69, s57, 20
    s_sub_u32 s58, s3, 1
    s_lshl_b32 s58, s58, 12
    s_waitcnt lgkmcnt(0)
    s_add_u32 s32, s6, s56
    s_addc_u32 s33, s7, 0
    s_add_u32 s36, s8, s56
    s_addc_u32 s37, s9, 0
    s_add_u32 s15, s69, s58
    s_xor_b32 s14, s15, s30
    s_cmp_eq_u32 s3, 0
    s_cbranch_scc1 L_w0
    buffer_load_dwordx4 v[36:39], v2, s[32:35], s14 offen offset:0 nt
    buffer_load_dwordx4 v[40:43], v2, s[32:35], s14 offen offset:1024 nt
    buffer_load_dwordx4 v[44:47], v2, s[32:35], s14 offen offset:2048 nt
    buffer_load_dwordx4 v[48:51], v2, s[32:35], s14 offen offset:3072 nt
    s_add_u32 s15, s15, 28672
    s_xor_b32 s14, s15, s30
    s_barrier
    s_mov_b32 s51, 0xffff0000
    s_mov_b32 s52, 0x3db504f3
    s_mov_b32 s53, 0x3db504f3
    s_mov_b32 s54, 0x3fb8aa3b
    s_mov_b32 s77, 16777216
    s_bfe_u32 s55, s2, 0x40003
    v_and_b32 v169, 1, v1
    v_lshlrev_b32 v169, 4, v169
    v_mov_b32 v170, 0xffff
    v_lshlrev_b32 v169, v169, v170
    v_bfe_u32 v170, v1, 1, 2
    v_cmp_eq_u32 vcc, 0, v170
    v_mov_b32 v16, 0
    s_nop 0
    v_cndmask_b32 v12, 0, v169, vcc
    v_cmp_eq_u32 vcc, 1, v170
    v_mov_b32 v17, 0
    s_nop 0
    v_cndmask_b32 v13, 0, v169, vcc
    v_cmp_eq_u32 vcc, 2, v170
    v_mov_b32 v18, 0
    s_nop 0
    v_cndmask_b32 v14, 0, v169, vcc
    v_cmp_eq_u32 vcc, 3, v170
    v_mov_b32 v19, 0
    s_nop 0
    v_cndmask_b32 v15, 0, v169, vcc
    v_mov_b32 v20, 0xff7fffff
    v_mov_b32 v21, 0
    s_and_b32 s56, s2, 7
    s_lshr_b32 s57, s2, 7
    s_lshl1_add_u32 s78, s56, s57
    v_bfe_u32 v28, v1, 3, 1
    v_lshlrev_b32 v28, 6, v28
    s_lshl_b32 s56, s3, 3
    v_add_u32 v28, s56, v28
    v_mov_b32 v26, 1
    v_mov_b32 v25, 4
    v_mov_b32 v27, 0
    s_mov_b32 s49, 1
    s_mov_b32 s71, 0
    v_mov_b32 v32, 0xff7fffff
    v_and_b32 v33, 60, v1
    v_add_u32 v33, 66560, v33
    s_add_u32 s68, s69, 1949696
    s_add_u32 s69, s69, 974848
    s_lshl_b32 s56, s3, 6
    s_add_u32 s66, s56, 3520
    s_add_u32 s67, s56, 3968
    s_sub_u32 s56, s56, 64
    v_add_u32 v178, s56, v33
    s_and_b32 s57, s3, 3
    s_lshl2_add_u32 s56, s55, s57
    s_mul_i32 s56, s56, 73728
    s_lshl_b32 s57, s57, 13
    s_add_u32 m0, s57, 33792
    s_min_u32 s57, s78, 8
    s_lshl_b32 s57, s57, 7
    s_add_u32 s56, s56, s57
    v_lshrrev_b32 v30, 3, v1
    v_mul_u32_u24 v30, 1152, v30
    v_and_b32 v169, 7, v1
    v_lshl_add_u32 v30, v169, 4, v30
    v_add_u32 v30, s56, v30
    s_sub_u32 s56, s3, 1
    s_lshl_b32 s56, s56, 1
    s_min_u32 s56, s56, 7
    s_lshl_b32 s56, s56, 6
    v_and_b32 v29, 15, v1
    v_lshl_add_u32 v29, v29, 2, s56
    s_lshr_b32 s56, s2, 7
    s_mul_i32 s56, s56, 1152
    v_lshrrev_b32 v169, 4, v1
    v_add_u32 v169, v169, v29
    v_lshl_add_u32 v169, v169, 1, s56
    s_waitcnt vmcnt(1)
    buffer_load_dwordx4 v[52:55], v2, s[32:35], s14 offen offset:0 nt
    buffer_load_dwordx4 v[56:59], v2, s[32:35], s14 offen offset:1024 nt
    buffer_load_dwordx4 v[60:63], v2, s[32:35], s14 offen offset:2048 nt
    buffer_load_dwordx4 v[64:67], v2, s[32:35], s14 offen offset:3072 nt
    s_add_u32 s15, s15, 28672
    s_xor_b32 s14, s15, s30
    s_waitcnt vmcnt(1)
    buffer_load_dwordx4 v[68:71], v2, s[32:35], s14 offen offset:0 nt
    buffer_load_dwordx4 v[72:75], v2, s[32:35], s14 offen offset:1024 nt
    buffer_load_dwordx4 v[76:79], v2, s[32:35], s14 offen offset:2048 nt
    buffer_load_dwordx4 v[80:83], v2, s[32:35], s14 offen offset:3072 nt
    s_add_u32 s15, s15, 28672
    s_xor_b32 s14, s15, s30
    s_waitcnt vmcnt(1)
    buffer_load_dwordx4 v[84:87], v2, s[32:35], s14 offen offset:0 nt
    buffer_load_dwordx4 v[88:91], v2, s[32:35], s14 offen offset:1024 nt
    buffer_load_dwordx4 v[92:95], v2, s[32:35], s14 offen offset:2048 nt
    buffer_load_dwordx4 v[96:99], v2, s[32:35], s14 offen offset:3072 nt
    s_add_u32 s15, s15, 28672
    s_xor_b32 s14, s15, s30
    s_waitcnt vmcnt(1)
    buffer_load_dwordx4 v[100:103], v2, s[32:35], s14 offen offset:0 nt
    buffer_load_dwordx4 v[104:107], v2, s[32:35], s14 offen offset:1024 nt
    buffer_load_dwordx4 v[108:111], v2, s[32:35], s14 offen offset:2048 nt
    buffer_load_dwordx4 v[112:115], v2, s[32:35], s14 offen offset:3072 nt
    s_add_u32 s15, s15, 28672
    s_xor_b32 s14, s15, s30
    s_waitcnt vmcnt(1)
    buffer_load_dwordx4 v[116:119], v2, s[32:35], s14 offen offset:0 nt
    buffer_load_dwordx4 v[120:123], v2, s[32:35], s14 offen offset:1024 nt
    buffer_load_dwordx4 v[124:127], v2, s[32:35], s14 offen offset:2048 nt
    buffer_load_dwordx4 v[128:131], v2, s[32:35], s14 offen offset:3072 nt
    s_add_u32 s15, s15, 28672
    s_xor_b32 s14, s15, s30
    s_and_b32 s56, s2, 127
    s_cmp_lg_u32 s56, 7
    s_cbranch_scc1 L_nx
    global_load_ushort v22, v169, s[4:5] offset:0
    global_load_ushort v23, v169, s[4:5] offset:128
L_nx:
    s_waitcnt vmcnt(1)
    buffer_load_dwordx4 v[132:135], v2, s[32:35], s14 offen offset:0 nt
    buffer_load_dwordx4 v[136:139], v2, s[32:35], s14 offen offset:1024 nt
    buffer_load_dwordx4 v[140:143], v2, s[32:35], s14 offen offset:2048 nt
    buffer_load_dwordx4 v[144:147], v2, s[32:35], s14 offen offset:3072 nt
    s_add_u32 s15, s15, 28672
    s_xor_b32 s14, s15, s30
    s_waitcnt vmcnt(1)
    buffer_load_dwordx4 v[148:151], v2, s[32:35], s14 offen offset:0 nt
    buffer_load_dwordx4 v[152:155], v2, s[32:35], s14 offen offset:1024 nt
    buffer_load_dwordx4 v[156:159], v2, s[32:35], s14 offen offset:2048 nt
    buffer_load_dwordx4 v[160:163], v2, s[32:35], s14 offen offset:3072 nt
    s_add_u32 s15, s15, 28672
    s_xor_b32 s14, s15, s30
    s_waitcnt vmcnt(1)
    buffer_load_dwordx4 v[212:215], v2, s[32:35], s14 offen offset:0 nt
    buffer_load_dwordx4 v[216:219], v2, s[32:35], s14 offen offset:1024 nt
    buffer_load_dwordx4 v[220:223], v2, s[32:35], s14 offen offset:2048 nt
    buffer_load_dwordx4 v[224:227], v2, s[32:35], s14 offen offset:3072 nt
    s_add_u32 s15, s15, 28672
    s_xor_b32 s14, s15, s30
    s_waitcnt vmcnt(1)
    buffer_load_dwordx4 v[228:231], v2, s[32:35], s14 offen offset:0 nt
    buffer_load_dwordx4 v[232:235], v2, s[32:35], s14 offen offset:1024 nt
    buffer_load_dwordx4 v[236:239], v2, s[32:35], s14 offen offset:2048 nt
    buffer_load_dwordx4 v[240:243], v2, s[32:35], s14 offen offset:3072 nt
    s_add_u32 s15, s15, 28672
    s_xor_b32 s14, s15, s30
    v_bfe_u32 v164, v1, 3, 1
    v_lshlrev_b32 v164, 8, v164
    v_and_b32 v165, 0xf0, v2
    v_add_u32 v164, v164, v165
    v_and_b32 v165, 4, v1
    v_cmp_eq_u32 vcc, 0, v165
L_qw:
    ds_read_b64 v[170:171], v27 offset:768
    ds_read_b128 v[172:175], v164 offset:0
    s_waitcnt lgkmcnt(0)
    v_readfirstlane_b32 s56, v171
    v_readfirstlane_b32 s50, v170
    s_cmp_lg_u32 s56, 0
    s_cbranch_scc1 L_qgo
    s_sleep 1
    s_sub_u32 s77, s77, 1
    s_cbranch_scc1 L_end
    s_branch L_qw
L_qgo:
    v_cndmask_b32 v4, 0, v172, vcc
    v_cndmask_b32 v8, v172, v27, vcc
    v_cndmask_b32 v5, 0, v173, vcc
    v_cndmask_b32 v9, v173, v27, vcc
    v_cndmask_b32 v6, 0, v174, vcc
    v_cndmask_b32 v10, v174, v27, vcc
    v_cndmask_b32 v7, 0, v175, vcc
    v_cndmask_b32 v11, v175, v27, vcc
    v_lshrrev_b32 v165, 2, v1
    v_lshlrev_b32 v164, 2, v165
    v_alignbit_b32 v164, s50, s50, v164
    v_xor_b32 v31, s50, v165
    v_bfi_b32 v31, 1, v31, v164
    s_cmp_lt_u32 s3, 4
    s_cbranch_scc1 L_x0
    s_setprio 1
L_k0:
    s_waitcnt vmcnt(4)
    s_mov_b64 exec, 1
    ds_add_rtn_u32 v179, v27, v25 offset:780
    s_mov_b64 exec, -1
    v_add_u32 v174, s66, v33
    s_waitcnt vmcnt(4) lgkmcnt(0)
    v_readfirstlane_b32 s56, v179
    v_mfma_f32_16x16x32_bf16 v[196:199], v[212:215], v[4:7], 0
    v_mfma_f32_16x16x32_bf16 v[200:203], v[220:223], v[4:7], 0
    v_mfma_f32_16x16x32_bf16 v[196:199], v[216:219], v[8:11], v[196:199]
    v_mfma_f32_16x16x32_bf16 v[200:203], v[224:227], v[8:11], v[200:203]
    s_nop 7
    v_mov_b32_dpp v164, v196 quad_perm:[0,0,0,0] row_mask:0xf bank_mask:0xf
    v_mov_b32_dpp v165, v200 quad_perm:[0,0,0,0] row_mask:0xf bank_mask:0xf
    v_mov_b32_dpp v166, v198 quad_perm:[2,2,2,2] row_mask:0xf bank_mask:0xf
    v_mov_b32_dpp v167, v202 quad_perm:[2,2,2,2] row_mask:0xf bank_mask:0xf
    v_add_f32_dpp v164, v197, v164 quad_perm:[1,1,1,1] row_mask:0xf bank_mask:0xf
    v_add_f32_dpp v165, v201, v165 quad_perm:[1,1,1,1] row_mask:0xf bank_mask:0xf
    v_add_f32_dpp v166, v199, v166 quad_perm:[3,3,3,3] row_mask:0xf bank_mask:0xf
    v_add_f32_dpp v167, v203, v167 quad_perm:[3,3,3,3] row_mask:0xf bank_mask:0xf
    v_pk_add_f32 v[164:165], v[164:165], v[166:167]
    v_cvt_pk_bf16_f32 v172, v164, v165
    v_lshlrev_b32 v164, 16, v172
    v_and_b32 v165, s51, v172
    v_pk_mul_f32 v[164:165], v[164:165], s[52:53]
    v_cvt_pk_bf16_f32 v172, v164, v165
    v_lshlrev_b32 v164, 16, v172
    v_and_b32 v165, s51, v172
    s_lshl_b32 s14, s56, 10
    s_lshl_b32 s66, s56, 4
    s_cmp_ge_i32 s56, -952
    s_cbranch_scc1 L_kv0
    s_add_u32 s14, s14, s68
    s_xor_b32 s14, s14, s30
    s_add_u32 s66, s66, 30464
    buffer_load_dwordx4 v[212:215], v2, s[32:35], s14 offen offset:0 nt
    buffer_load_dwordx4 v[216:219], v2, s[32:35], s14 offen offset:1024 nt
    buffer_load_dwordx4 v[220:223], v2, s[32:35], s14 offen offset:2048 nt
    buffer_load_dwordx4 v[224:227], v2, s[32:35], s14 offen offset:3072 nt
L_kf0:
    ds_write_b32 v174, v172
    v_max3_f32 v32, v32, v164, v165
    s_cmp_eq_u32 s71, 2
    s_cbranch_scc1 L_ks
    s_waitcnt vmcnt(4)
    s_mov_b64 exec, 1
    ds_add_rtn_u32 v179, v27, v25 offset:780
    s_mov_b64 exec, -1
    v_add_u32 v174, s67, v33
    s_waitcnt vmcnt(4) lgkmcnt(0)
    v_readfirstlane_b32 s56, v179
    v_mfma_f32_16x16x32_bf16 v[196:199], v[228:231], v[4:7], 0
    v_mfma_f32_16x16x32_bf16 v[200:203], v[236:239], v[4:7], 0
    v_mfma_f32_16x16x32_bf16 v[196:199], v[232:235], v[8:11], v[196:199]
    v_mfma_f32_16x16x32_bf16 v[200:203], v[240:243], v[8:11], v[200:203]
    s_nop 7
    v_mov_b32_dpp v164, v196 quad_perm:[0,0,0,0] row_mask:0xf bank_mask:0xf
    v_mov_b32_dpp v165, v200 quad_perm:[0,0,0,0] row_mask:0xf bank_mask:0xf
    v_mov_b32_dpp v166, v198 quad_perm:[2,2,2,2] row_mask:0xf bank_mask:0xf
    v_mov_b32_dpp v167, v202 quad_perm:[2,2,2,2] row_mask:0xf bank_mask:0xf
    v_add_f32_dpp v164, v197, v164 quad_perm:[1,1,1,1] row_mask:0xf bank_mask:0xf
    v_add_f32_dpp v165, v201, v165 quad_perm:[1,1,1,1] row_mask:0xf bank_mask:0xf
    v_add_f32_dpp v166, v199, v166 quad_perm:[3,3,3,3] row_mask:0xf bank_mask:0xf
    v_add_f32_dpp v167, v203, v167 quad_perm:[3,3,3,3] row_mask:0xf bank_mask:0xf
    v_pk_add_f32 v[164:165], v[164:165], v[166:167]
    v_cvt_pk_bf16_f32 v172, v164, v165
    v_lshlrev_b32 v164, 16, v172
    v_and_b32 v165, s51, v172
    v_pk_mul_f32 v[164:165], v[164:165], s[52:53]
    v_cvt_pk_bf16_f32 v172, v164, v165
    v_lshlrev_b32 v164, 16, v172
    v_and_b32 v165, s51, v172
    s_lshl_b32 s14, s56, 10
    s_lshl_b32 s67, s56, 4
    s_cmp_ge_i32 s56, -952
    s_cbranch_scc1 L_kv1
    s_add_u32 s14, s14, s68
    s_xor_b32 s14, s14, s30
    s_add_u32 s67, s67, 30464
    buffer_load_dwordx4 v[228:231], v2, s[32:35], s14 offen offset:0 nt
    buffer_load_dwordx4 v[232:235], v2, s[32:35], s14 offen offset:1024 nt
    buffer_load_dwordx4 v[236:239], v2, s[32:35], s14 offen offset:2048 nt
    buffer_load_dwordx4 v[240:243], v2, s[32:35], s14 offen offset:3072 nt
L_kf1:
    ds_write_b32 v174, v172
    v_max3_f32 v32, v32, v164, v165
    s_add_u32 s49, s49, 1
    s_cmp_eq_u32 s49, 2
    s_cbranch_scc1 L_x1
    s_cmp_lg_u32 s71, 2
    s_cbranch_scc1 L_k0
    s_mov_b32 s71, 0
L_ks:
    v_lshrrev_b32 v164, 1, v1
    v_and_b32 v164, 4, v164
    ds_max_f32 v164, v32 offset:792
    s_mov_b64 exec, 1
    ds_add_u32 v27, v26 offset:788
    s_mov_b64 exec, -1
L_kw:
    ds_read_b32 v166, v27 offset:788
    ds_read_b32 v20, v164 offset:792
    s_waitcnt lgkmcnt(0)
    v_readfirstlane_b32 s56, v166
    s_sub_u32 s77, s77, 1
    s_cbranch_scc1 L_end
    s_cmp_lg_u32 s56, 7
    s_cbranch_scc1 L_kw
    v_mul_f32 v20, s54, v20
    s_cmp_eq_u32 s71, 2
    s_cbranch_scc1 L_v1
L_v0:
    s_waitcnt vmcnt(4)
    v_add_u32 v174, s66, v33
    ds_read_b32 v172, v174
    s_mov_b64 exec, 1
    ds_add_rtn_u32 v179, v27, v25 offset:780
    s_mov_b64 exec, -1
    s_waitcnt lgkmcnt(0)
    v_lshlrev_b32 v164, 16, v172
    v_and_b32 v165, s51, v172
    v_readfirstlane_b32 s56, v179
    v_fma_f32 v164, v164, s54, -v20
    v_fma_f32 v165, v165, s54, -v20
    v_exp_f32 v164, v164
    v_exp_f32 v165, v165
    s_lshl_b32 s14, s56, 10
    s_lshl_b32 s66, s56, 4
    s_add_u32 s14, s14, s69
    s_xor_b32 s14, s14, s30
    s_add_u32 s66, s66, 15232
    v_cvt_pk_bf16_f32 v168, v164, v164
    v_cvt_pk_bf16_f32 v169, v165, v165
    v_add_f32 v21, v21, v164
    v_add_f32 v21, v21, v165
    v_and_b32 v180, v168, v12
    v_and_b32 v181, v168, v13
    v_and_b32_dpp v182, v168, v14 row_half_mirror row_mask:0xf bank_mask:0xf
    v_and_b32_dpp v183, v168, v15 row_half_mirror row_mask:0xf bank_mask:0xf
    v_and_b32_dpp v184, v168, v12 row_half_mirror row_mask:0xf bank_mask:0xf
    v_and_b32_dpp v185, v168, v13 row_half_mirror row_mask:0xf bank_mask:0xf
    v_and_b32 v186, v168, v14
    v_and_b32 v187, v168, v15
    v_and_b32 v188, v169, v12
    v_and_b32 v189, v169, v13
    v_and_b32_dpp v190, v169, v14 row_half_mirror row_mask:0xf bank_mask:0xf
    v_and_b32_dpp v191, v169, v15 row_half_mirror row_mask:0xf bank_mask:0xf
    v_and_b32_dpp v192, v169, v12 row_half_mirror row_mask:0xf bank_mask:0xf
    v_and_b32_dpp v193, v169, v13 row_half_mirror row_mask:0xf bank_mask:0xf
    v_and_b32 v194, v169, v14
    v_and_b32 v195, v169, v15
    v_mfma_f32_16x16x32_bf16 v[16:19], v[212:215], v[180:183], v[16:19]
    v_mfma_f32_16x16x32_bf16 v[16:19], v[216:219], v[184:187], v[16:19]
    v_mfma_f32_16x16x32_bf16 v[16:19], v[220:223], v[188:191], v[16:19]
    v_mfma_f32_16x16x32_bf16 v[16:19], v[224:227], v[192:195], v[16:19]
    s_cmp_ge_i32 s56, 0
    s_cbranch_scc1 L_vf0
    buffer_load_dwordx4 v[212:215], v3, s[36:39], s14 offen offset:0 nt
    buffer_load_dwordx4 v[216:219], v3, s[36:39], s14 offen offset:1024 nt
    buffer_load_dwordx4 v[220:223], v3, s[36:39], s14 offen offset:2048 nt
    buffer_load_dwordx4 v[224:227], v3, s[36:39], s14 offen offset:3072 nt
L_v1:
    s_waitcnt vmcnt(4)
    v_add_u32 v174, s67, v33
    ds_read_b32 v172, v174
    s_mov_b64 exec, 1
    ds_add_rtn_u32 v179, v27, v25 offset:780
    s_mov_b64 exec, -1
    s_waitcnt lgkmcnt(0)
    v_lshlrev_b32 v164, 16, v172
    v_and_b32 v165, s51, v172
    v_readfirstlane_b32 s56, v179
    v_fma_f32 v164, v164, s54, -v20
    v_fma_f32 v165, v165, s54, -v20
    v_exp_f32 v164, v164
    v_exp_f32 v165, v165
    s_lshl_b32 s14, s56, 10
    s_lshl_b32 s67, s56, 4
    s_add_u32 s14, s14, s69
    s_xor_b32 s14, s14, s30
    s_add_u32 s67, s67, 15232
    v_cvt_pk_bf16_f32 v168, v164, v164
    v_cvt_pk_bf16_f32 v169, v165, v165
    v_add_f32 v21, v21, v164
    v_add_f32 v21, v21, v165
    v_and_b32 v180, v168, v12
    v_and_b32 v181, v168, v13
    v_and_b32_dpp v182, v168, v14 row_half_mirror row_mask:0xf bank_mask:0xf
    v_and_b32_dpp v183, v168, v15 row_half_mirror row_mask:0xf bank_mask:0xf
    v_and_b32_dpp v184, v168, v12 row_half_mirror row_mask:0xf bank_mask:0xf
    v_and_b32_dpp v185, v168, v13 row_half_mirror row_mask:0xf bank_mask:0xf
    v_and_b32 v186, v168, v14
    v_and_b32 v187, v168, v15
    v_and_b32 v188, v169, v12
    v_and_b32 v189, v169, v13
    v_and_b32_dpp v190, v169, v14 row_half_mirror row_mask:0xf bank_mask:0xf
    v_and_b32_dpp v191, v169, v15 row_half_mirror row_mask:0xf bank_mask:0xf
    v_and_b32_dpp v192, v169, v12 row_half_mirror row_mask:0xf bank_mask:0xf
    v_and_b32_dpp v193, v169, v13 row_half_mirror row_mask:0xf bank_mask:0xf
    v_and_b32 v194, v169, v14
    v_and_b32 v195, v169, v15
    v_mfma_f32_16x16x32_bf16 v[16:19], v[228:231], v[180:183], v[16:19]
    v_mfma_f32_16x16x32_bf16 v[16:19], v[232:235], v[184:187], v[16:19]
    v_mfma_f32_16x16x32_bf16 v[16:19], v[236:239], v[188:191], v[16:19]
    v_mfma_f32_16x16x32_bf16 v[16:19], v[240:243], v[192:195], v[16:19]
    s_cmp_ge_i32 s56, 0
    s_cbranch_scc1 L_vf1
    buffer_load_dwordx4 v[228:231], v3, s[36:39], s14 offen offset:0 nt
    buffer_load_dwordx4 v[232:235], v3, s[36:39], s14 offen offset:1024 nt
    buffer_load_dwordx4 v[236:239], v3, s[36:39], s14 offen offset:2048 nt
    buffer_load_dwordx4 v[240:243], v3, s[36:39], s14 offen offset:3072 nt
    s_branch L_v0
L_kv0:
    s_add_u32 s14, s14, s69
    s_xor_b32 s14, s14, s30
    s_add_u32 s66, s66, 15232
    s_add_u32 s71, s71, 1
    buffer_load_dwordx4 v[212:215], v3, s[36:39], s14 offen offset:0 nt
    buffer_load_dwordx4 v[216:219], v3, s[36:39], s14 offen offset:1024 nt
    buffer_load_dwordx4 v[220:223], v3, s[36:39], s14 offen offset:2048 nt
    buffer_load_dwordx4 v[224:227], v3, s[36:39], s14 offen offset:3072 nt
    s_branch L_kf0
L_kv1:
    s_add_u32 s14, s14, s69
    s_xor_b32 s14, s14, s30
    s_add_u32 s67, s67, 15232
    s_add_u32 s71, s71, 1
    buffer_load_dwordx4 v[228:231], v3, s[36:39], s14 offen offset:0 nt
    buffer_load_dwordx4 v[232:235], v3, s[36:39], s14 offen offset:1024 nt
    buffer_load_dwordx4 v[236:239], v3, s[36:39], s14 offen offset:2048 nt
    buffer_load_dwordx4 v[240:243], v3, s[36:39], s14 offen offset:3072 nt
    s_branch L_kf1
L_x0:
    s_waitcnt vmcnt(8)
L_x1:
    v_mfma_f32_16x16x32_bf16 v[180:183], v[36:39], v[4:7], 0
    v_mfma_f32_16x16x32_bf16 v[184:187], v[44:47], v[4:7], 0
    v_mfma_f32_16x16x32_bf16 v[188:191], v[52:55], v[4:7], 0
    v_mfma_f32_16x16x32_bf16 v[192:195], v[60:63], v[4:7], 0
    v_mfma_f32_16x16x32_bf16 v[180:183], v[40:43], v[8:11], v[180:183]
    v_mfma_f32_16x16x32_bf16 v[184:187], v[48:51], v[8:11], v[184:187]
    v_mfma_f32_16x16x32_bf16 v[188:191], v[56:59], v[8:11], v[188:191]
    v_mfma_f32_16x16x32_bf16 v[192:195], v[64:67], v[8:11], v[192:195]
    s_nop 7
    v_mov_b32_dpp v164, v180 quad_perm:[0,0,0,0] row_mask:0xf bank_mask:0xf
    v_mov_b32_dpp v165, v184 quad_perm:[0,0,0,0] row_mask:0xf bank_mask:0xf
    v_mov_b32_dpp v166, v188 quad_perm:[0,0,0,0] row_mask:0xf bank_mask:0xf
    v_mov_b32_dpp v167, v192 quad_perm:[0,0,0,0] row_mask:0xf bank_mask:0xf
    v_add_f32_dpp v164, v181, v164 quad_perm:[1,1,1,1] row_mask:0xf bank_mask:0xf
    v_add_f32_dpp v165, v185, v165 quad_perm:[1,1,1,1] row_mask:0xf bank_mask:0xf
    v_add_f32_dpp v166, v189, v166 quad_perm:[1,1,1,1] row_mask:0xf bank_mask:0xf
    v_add_f32_dpp v167, v193, v167 quad_perm:[1,1,1,1] row_mask:0xf bank_mask:0xf
    v_add_f32_dpp v164, v182, v164 quad_perm:[2,2,2,2] row_mask:0xf bank_mask:0xf
    v_add_f32_dpp v165, v186, v165 quad_perm:[2,2,2,2] row_mask:0xf bank_mask:0xf
    v_add_f32_dpp v166, v190, v166 quad_perm:[2,2,2,2] row_mask:0xf bank_mask:0xf
    v_add_f32_dpp v167, v194, v167 quad_perm:[2,2,2,2] row_mask:0xf bank_mask:0xf
    v_add_f32_dpp v164, v183, v164 quad_perm:[3,3,3,3] row_mask:0xf bank_mask:0xf
    v_add_f32_dpp v165, v187, v165 quad_perm:[3,3,3,3] row_mask:0xf bank_mask:0xf
    v_add_f32_dpp v166, v191, v166 quad_perm:[3,3,3,3] row_mask:0xf bank_mask:0xf
    v_add_f32_dpp v167, v195, v167 quad_perm:[3,3,3,3] row_mask:0xf bank_mask:0xf
    v_cvt_pk_bf16_f32 v172, v164, v165
    v_cvt_pk_bf16_f32 v173, v166, v167
    v_lshlrev_b32 v164, 16, v172
    v_and_b32 v165, s51, v172
    v_lshlrev_b32 v166, 16, v173
    v_and_b32 v167, s51, v173
    v_pk_mul_f32 v[164:165], v[164:165], s[52:53]
    v_pk_mul_f32 v[166:167], v[166:167], s[52:53]
    v_cvt_pk_bf16_f32 v172, v164, v165
    v_cvt_pk_bf16_f32 v173, v166, v167
    v_lshlrev_b32 v164, 16, v172
    v_and_b32 v165, s51, v172
    v_lshlrev_b32 v166, 16, v173
    v_and_b32 v167, s51, v173
    ds_write_b32 v178, v172 offset:0
    ds_write_b32 v178, v173 offset:448
    v_max3_f32 v32, v32, v164, v165
    v_max3_f32 v32, v32, v166, v167
    v_mfma_f32_16x16x32_bf16 v[180:183], v[68:71], v[4:7], 0
    v_mfma_f32_16x16x32_bf16 v[184:187], v[76:79], v[4:7], 0
    v_mfma_f32_16x16x32_bf16 v[188:191], v[84:87], v[4:7], 0
    v_mfma_f32_16x16x32_bf16 v[192:195], v[92:95], v[4:7], 0
    v_mfma_f32_16x16x32_bf16 v[180:183], v[72:75], v[8:11], v[180:183]
    v_mfma_f32_16x16x32_bf16 v[184:187], v[80:83], v[8:11], v[184:187]
    v_mfma_f32_16x16x32_bf16 v[188:191], v[88:91], v[8:11], v[188:191]
    v_mfma_f32_16x16x32_bf16 v[192:195], v[96:99], v[8:11], v[192:195]
    s_nop 7
    v_mov_b32_dpp v164, v180 quad_perm:[0,0,0,0] row_mask:0xf bank_mask:0xf
    v_mov_b32_dpp v165, v184 quad_perm:[0,0,0,0] row_mask:0xf bank_mask:0xf
    v_mov_b32_dpp v166, v188 quad_perm:[0,0,0,0] row_mask:0xf bank_mask:0xf
    v_mov_b32_dpp v167, v192 quad_perm:[0,0,0,0] row_mask:0xf bank_mask:0xf
    v_add_f32_dpp v164, v181, v164 quad_perm:[1,1,1,1] row_mask:0xf bank_mask:0xf
    v_add_f32_dpp v165, v185, v165 quad_perm:[1,1,1,1] row_mask:0xf bank_mask:0xf
    v_add_f32_dpp v166, v189, v166 quad_perm:[1,1,1,1] row_mask:0xf bank_mask:0xf
    v_add_f32_dpp v167, v193, v167 quad_perm:[1,1,1,1] row_mask:0xf bank_mask:0xf
    v_add_f32_dpp v164, v182, v164 quad_perm:[2,2,2,2] row_mask:0xf bank_mask:0xf
    v_add_f32_dpp v165, v186, v165 quad_perm:[2,2,2,2] row_mask:0xf bank_mask:0xf
    v_add_f32_dpp v166, v190, v166 quad_perm:[2,2,2,2] row_mask:0xf bank_mask:0xf
    v_add_f32_dpp v167, v194, v167 quad_perm:[2,2,2,2] row_mask:0xf bank_mask:0xf
    v_add_f32_dpp v164, v183, v164 quad_perm:[3,3,3,3] row_mask:0xf bank_mask:0xf
    v_add_f32_dpp v165, v187, v165 quad_perm:[3,3,3,3] row_mask:0xf bank_mask:0xf
    v_add_f32_dpp v166, v191, v166 quad_perm:[3,3,3,3] row_mask:0xf bank_mask:0xf
    v_add_f32_dpp v167, v195, v167 quad_perm:[3,3,3,3] row_mask:0xf bank_mask:0xf
    v_cvt_pk_bf16_f32 v172, v164, v165
    v_cvt_pk_bf16_f32 v173, v166, v167
    v_lshlrev_b32 v164, 16, v172
    v_and_b32 v165, s51, v172
    v_lshlrev_b32 v166, 16, v173
    v_and_b32 v167, s51, v173
    v_pk_mul_f32 v[164:165], v[164:165], s[52:53]
    v_pk_mul_f32 v[166:167], v[166:167], s[52:53]
    v_cvt_pk_bf16_f32 v172, v164, v165
    v_cvt_pk_bf16_f32 v173, v166, v167
    v_lshlrev_b32 v164, 16, v172
    v_and_b32 v165, s51, v172
    v_lshlrev_b32 v166, 16, v173
    v_and_b32 v167, s51, v173
    ds_write_b32 v178, v172 offset:896
    ds_write_b32 v178, v173 offset:1344
    v_max3_f32 v32, v32, v164, v165
    v_max3_f32 v32, v32, v166, v167
    v_mfma_f32_16x16x32_bf16 v[180:183], v[100:103], v[4:7], 0
    v_mfma_f32_16x16x32_bf16 v[184:187], v[108:111], v[4:7], 0
    v_mfma_f32_16x16x32_bf16 v[188:191], v[116:119], v[4:7], 0
    v_mfma_f32_16x16x32_bf16 v[192:195], v[124:127], v[4:7], 0
    v_mfma_f32_16x16x32_bf16 v[180:183], v[104:107], v[8:11], v[180:183]
    v_mfma_f32_16x16x32_bf16 v[184:187], v[112:115], v[8:11], v[184:187]
    v_mfma_f32_16x16x32_bf16 v[188:191], v[120:123], v[8:11], v[188:191]
    v_mfma_f32_16x16x32_bf16 v[192:195], v[128:131], v[8:11], v[192:195]
    s_nop 7
    v_mov_b32_dpp v164, v180 quad_perm:[0,0,0,0] row_mask:0xf bank_mask:0xf
    v_mov_b32_dpp v165, v184 quad_perm:[0,0,0,0] row_mask:0xf bank_mask:0xf
    v_mov_b32_dpp v166, v188 quad_perm:[0,0,0,0] row_mask:0xf bank_mask:0xf
    v_mov_b32_dpp v167, v192 quad_perm:[0,0,0,0] row_mask:0xf bank_mask:0xf
    v_add_f32_dpp v164, v181, v164 quad_perm:[1,1,1,1] row_mask:0xf bank_mask:0xf
    v_add_f32_dpp v165, v185, v165 quad_perm:[1,1,1,1] row_mask:0xf bank_mask:0xf
    v_add_f32_dpp v166, v189, v166 quad_perm:[1,1,1,1] row_mask:0xf bank_mask:0xf
    v_add_f32_dpp v167, v193, v167 quad_perm:[1,1,1,1] row_mask:0xf bank_mask:0xf
    v_add_f32_dpp v164, v182, v164 quad_perm:[2,2,2,2] row_mask:0xf bank_mask:0xf
    v_add_f32_dpp v165, v186, v165 quad_perm:[2,2,2,2] row_mask:0xf bank_mask:0xf
    v_add_f32_dpp v166, v190, v166 quad_perm:[2,2,2,2] row_mask:0xf bank_mask:0xf
    v_add_f32_dpp v167, v194, v167 quad_perm:[2,2,2,2] row_mask:0xf bank_mask:0xf
    v_add_f32_dpp v164, v183, v164 quad_perm:[3,3,3,3] row_mask:0xf bank_mask:0xf
    v_add_f32_dpp v165, v187, v165 quad_perm:[3,3,3,3] row_mask:0xf bank_mask:0xf
    v_add_f32_dpp v166, v191, v166 quad_perm:[3,3,3,3] row_mask:0xf bank_mask:0xf
    v_add_f32_dpp v167, v195, v167 quad_perm:[3,3,3,3] row_mask:0xf bank_mask:0xf
    v_cvt_pk_bf16_f32 v172, v164, v165
    v_cvt_pk_bf16_f32 v173, v166, v167
    v_lshlrev_b32 v164, 16, v172
    v_and_b32 v165, s51, v172
    v_lshlrev_b32 v166, 16, v173
    v_and_b32 v167, s51, v173
    v_pk_mul_f32 v[164:165], v[164:165], s[52:53]
    v_pk_mul_f32 v[166:167], v[166:167], s[52:53]
    v_cvt_pk_bf16_f32 v172, v164, v165
    v_cvt_pk_bf16_f32 v173, v166, v167
    v_lshlrev_b32 v164, 16, v172
    v_and_b32 v165, s51, v172
    v_lshlrev_b32 v166, 16, v173
    v_and_b32 v167, s51, v173
    ds_write_b32 v178, v172 offset:1792
    ds_write_b32 v178, v173 offset:2240
    v_max3_f32 v32, v32, v164, v165
    v_max3_f32 v32, v32, v166, v167
    v_mfma_f32_16x16x32_bf16 v[180:183], v[132:135], v[4:7], 0
    v_mfma_f32_16x16x32_bf16 v[184:187], v[140:143], v[4:7], 0
    v_mfma_f32_16x16x32_bf16 v[188:191], v[148:151], v[4:7], 0
    v_mfma_f32_16x16x32_bf16 v[192:195], v[156:159], v[4:7], 0
    v_mfma_f32_16x16x32_bf16 v[180:183], v[136:139], v[8:11], v[180:183]
    v_mfma_f32_16x16x32_bf16 v[184:187], v[144:147], v[8:11], v[184:187]
    v_mfma_f32_16x16x32_bf16 v[188:191], v[152:155], v[8:11], v[188:191]
    v_mfma_f32_16x16x32_bf16 v[192:195], v[160:163], v[8:11], v[192:195]
    s_nop 7
    v_mov_b32_dpp v164, v180 quad_perm:[0,0,0,0] row_mask:0xf bank_mask:0xf
    v_mov_b32_dpp v165, v184 quad_perm:[0,0,0,0] row_mask:0xf bank_mask:0xf
    v_mov_b32_dpp v166, v188 quad_perm:[0,0,0,0] row_mask:0xf bank_mask:0xf
    v_mov_b32_dpp v167, v192 quad_perm:[0,0,0,0] row_mask:0xf bank_mask:0xf
    v_add_f32_dpp v164, v181, v164 quad_perm:[1,1,1,1] row_mask:0xf bank_mask:0xf
    v_add_f32_dpp v165, v185, v165 quad_perm:[1,1,1,1] row_mask:0xf bank_mask:0xf
    v_add_f32_dpp v166, v189, v166 quad_perm:[1,1,1,1] row_mask:0xf bank_mask:0xf
    v_add_f32_dpp v167, v193, v167 quad_perm:[1,1,1,1] row_mask:0xf bank_mask:0xf
    v_add_f32_dpp v164, v182, v164 quad_perm:[2,2,2,2] row_mask:0xf bank_mask:0xf
    v_add_f32_dpp v165, v186, v165 quad_perm:[2,2,2,2] row_mask:0xf bank_mask:0xf
    v_add_f32_dpp v166, v190, v166 quad_perm:[2,2,2,2] row_mask:0xf bank_mask:0xf
    v_add_f32_dpp v167, v194, v167 quad_perm:[2,2,2,2] row_mask:0xf bank_mask:0xf
    v_add_f32_dpp v164, v183, v164 quad_perm:[3,3,3,3] row_mask:0xf bank_mask:0xf
    v_add_f32_dpp v165, v187, v165 quad_perm:[3,3,3,3] row_mask:0xf bank_mask:0xf
    v_add_f32_dpp v166, v191, v166 quad_perm:[3,3,3,3] row_mask:0xf bank_mask:0xf
    v_add_f32_dpp v167, v195, v167 quad_perm:[3,3,3,3] row_mask:0xf bank_mask:0xf
    v_cvt_pk_bf16_f32 v172, v164, v165
    v_cvt_pk_bf16_f32 v173, v166, v167
    v_lshlrev_b32 v164, 16, v172
    v_and_b32 v165, s51, v172
    v_lshlrev_b32 v166, 16, v173
    v_and_b32 v167, s51, v173
    v_pk_mul_f32 v[164:165], v[164:165], s[52:53]
    v_pk_mul_f32 v[166:167], v[166:167], s[52:53]
    v_cvt_pk_bf16_f32 v172, v164, v165
    v_cvt_pk_bf16_f32 v173, v166, v167
    v_lshlrev_b32 v164, 16, v172
    v_and_b32 v165, s51, v172
    v_lshlrev_b32 v166, 16, v173
    v_and_b32 v167, s51, v173
    ds_write_b32 v178, v172 offset:2688
    ds_write_b32 v178, v173 offset:3136
    v_max3_f32 v32, v32, v164, v165
    v_max3_f32 v32, v32, v166, v167
    s_cmp_ge_u32 s3, 4
    s_cbranch_scc1 L_k0
    s_waitcnt vmcnt(0)
    v_mfma_f32_16x16x32_bf16 v[180:183], v[212:215], v[4:7], 0
    v_mfma_f32_16x16x32_bf16 v[184:187], v[220:223], v[4:7], 0
    v_mfma_f32_16x16x32_bf16 v[188:191], v[228:231], v[4:7], 0
    v_mfma_f32_16x16x32_bf16 v[192:195], v[236:239], v[4:7], 0
    v_mfma_f32_16x16x32_bf16 v[180:183], v[216:219], v[8:11], v[180:183]
    v_mfma_f32_16x16x32_bf16 v[184:187], v[224:227], v[8:11], v[184:187]
    v_mfma_f32_16x16x32_bf16 v[188:191], v[232:235], v[8:11], v[188:191]
    v_mfma_f32_16x16x32_bf16 v[192:195], v[240:243], v[8:11], v[192:195]
    s_nop 7
    v_mov_b32_dpp v164, v180 quad_perm:[0,0,0,0] row_mask:0xf bank_mask:0xf
    v_mov_b32_dpp v165, v184 quad_perm:[0,0,0,0] row_mask:0xf bank_mask:0xf
    v_mov_b32_dpp v166, v188 quad_perm:[0,0,0,0] row_mask:0xf bank_mask:0xf
    v_mov_b32_dpp v167, v192 quad_perm:[0,0,0,0] row_mask:0xf bank_mask:0xf
    v_add_f32_dpp v164, v181, v164 quad_perm:[1,1,1,1] row_mask:0xf bank_mask:0xf
    v_add_f32_dpp v165, v185, v165 quad_perm:[1,1,1,1] row_mask:0xf bank_mask:0xf
    v_add_f32_dpp v166, v189, v166 quad_perm:[1,1,1,1] row_mask:0xf bank_mask:0xf
    v_add_f32_dpp v167, v193, v167 quad_perm:[1,1,1,1] row_mask:0xf bank_mask:0xf
    v_add_f32_dpp v164, v182, v164 quad_perm:[2,2,2,2] row_mask:0xf bank_mask:0xf
    v_add_f32_dpp v165, v186, v165 quad_perm:[2,2,2,2] row_mask:0xf bank_mask:0xf
    v_add_f32_dpp v166, v190, v166 quad_perm:[2,2,2,2] row_mask:0xf bank_mask:0xf
    v_add_f32_dpp v167, v194, v167 quad_perm:[2,2,2,2] row_mask:0xf bank_mask:0xf
    v_add_f32_dpp v164, v183, v164 quad_perm:[3,3,3,3] row_mask:0xf bank_mask:0xf
    v_add_f32_dpp v165, v187, v165 quad_perm:[3,3,3,3] row_mask:0xf bank_mask:0xf
    v_add_f32_dpp v166, v191, v166 quad_perm:[3,3,3,3] row_mask:0xf bank_mask:0xf
    v_add_f32_dpp v167, v195, v167 quad_perm:[3,3,3,3] row_mask:0xf bank_mask:0xf
    v_cvt_pk_bf16_f32 v172, v164, v165
    v_cvt_pk_bf16_f32 v173, v166, v167
    v_lshlrev_b32 v164, 16, v172
    v_and_b32 v165, s51, v172
    v_lshlrev_b32 v166, 16, v173
    v_and_b32 v167, s51, v173
    v_pk_mul_f32 v[164:165], v[164:165], s[52:53]
    v_pk_mul_f32 v[166:167], v[166:167], s[52:53]
    v_cvt_pk_bf16_f32 v172, v164, v165
    v_cvt_pk_bf16_f32 v173, v166, v167
    v_lshlrev_b32 v164, 16, v172
    v_and_b32 v165, s51, v172
    v_lshlrev_b32 v166, 16, v173
    v_and_b32 v167, s51, v173
    ds_write_b32 v178, v172 offset:3584
    ds_write_b32 v178, v173 offset:4032
    v_max3_f32 v32, v32, v164, v165
    v_max3_f32 v32, v32, v166, v167
    v_lshrrev_b32 v164, 1, v1
    v_and_b32 v164, 4, v164
    ds_max_f32 v164, v32 offset:792
    s_mov_b64 exec, 1
    ds_add_u32 v27, v26 offset:788
    s_mov_b64 exec, -1
    s_branch L_help
L_vf1:
    s_waitcnt lgkmcnt(0)
    v_and_b32 v174, 0x7fc, v179
    ds_read_b32 v175, v174 offset:16384
L_rsv1:
    s_waitcnt lgkmcnt(0)
    v_readfirstlane_b32 s31, v175
    s_cmp_lg_u32 s31, -1
    s_cbranch_scc1 L_rkv1
    ds_read_b32 v175, v174 offset:16384
    s_sub_u32 s77, s77, 1
    s_cbranch_scc1 L_end
    s_branch L_rsv1
L_rkv1:
    s_mov_b32 s14, s31
    s_cmp_lg_u32 s31, -2
    s_cbranch_scc1 L_vg1
    s_waitcnt vmcnt(0)
    s_branch L_vh1
L_vg1:
    buffer_load_dwordx4 v[228:231], v3, s[36:39], s14 offen offset:0 nt
    buffer_load_dwordx4 v[232:235], v3, s[36:39], s14 offen offset:1024 nt
    buffer_load_dwordx4 v[236:239], v3, s[36:39], s14 offen offset:2048 nt
    buffer_load_dwordx4 v[240:243], v3, s[36:39], s14 offen offset:3072 nt
L_vh1:
    v_add_u32 v174, s66, v33
    ds_read_b32 v172, v174
    s_waitcnt lgkmcnt(0)
    v_lshlrev_b32 v164, 16, v172
    v_and_b32 v165, s51, v172
    v_fma_f32 v164, v164, s54, -v20
    v_fma_f32 v165, v165, s54, -v20
    v_exp_f32 v164, v164
    v_exp_f32 v165, v165
    s_nop 0
    v_cvt_pk_bf16_f32 v168, v164, v164
    v_cvt_pk_bf16_f32 v169, v165, v165
    v_add_f32 v21, v21, v164
    v_add_f32 v21, v21, v165
    v_and_b32 v180, v168, v12
    v_and_b32 v181, v168, v13
    v_and_b32_dpp v182, v168, v14 row_half_mirror row_mask:0xf bank_mask:0xf
    v_and_b32_dpp v183, v168, v15 row_half_mirror row_mask:0xf bank_mask:0xf
    v_and_b32_dpp v184, v168, v12 row_half_mirror row_mask:0xf bank_mask:0xf
    v_and_b32_dpp v185, v168, v13 row_half_mirror row_mask:0xf bank_mask:0xf
    v_and_b32 v186, v168, v14
    v_and_b32 v187, v168, v15
    v_and_b32 v188, v169, v12
    v_and_b32 v189, v169, v13
    v_and_b32_dpp v190, v169, v14 row_half_mirror row_mask:0xf bank_mask:0xf
    v_and_b32_dpp v191, v169, v15 row_half_mirror row_mask:0xf bank_mask:0xf
    v_and_b32_dpp v192, v169, v12 row_half_mirror row_mask:0xf bank_mask:0xf
    v_and_b32_dpp v193, v169, v13 row_half_mirror row_mask:0xf bank_mask:0xf
    v_and_b32 v194, v169, v14
    v_and_b32 v195, v169, v15
    s_waitcnt vmcnt(7)
    v_mfma_f32_16x16x32_bf16 v[16:19], v[212:215], v[180:183], v[16:19]
    s_waitcnt vmcnt(6)
    v_mfma_f32_16x16x32_bf16 v[16:19], v[216:219], v[184:187], v[16:19]
    s_waitcnt vmcnt(5)
    v_mfma_f32_16x16x32_bf16 v[16:19], v[220:223], v[188:191], v[16:19]
    s_waitcnt vmcnt(4)
    v_mfma_f32_16x16x32_bf16 v[16:19], v[224:227], v[192:195], v[16:19]
    s_cmp_eq_u32 s31, -2
    s_cbranch_scc1 L_fw
    buffer_load_dwordx4 v[212:215], v2, s[32:35], s14 offen offset:0 nt
    buffer_load_dwordx4 v[216:219], v2, s[32:35], s14 offen offset:1024 nt
    buffer_load_dwordx4 v[220:223], v2, s[32:35], s14 offen offset:2048 nt
    buffer_load_dwordx4 v[224:227], v2, s[32:35], s14 offen offset:3072 nt
    s_mov_b64 exec, 1
    ds_add_rtn_u32 v179, v27, v25 offset:780
    s_mov_b64 exec, -1
    s_waitcnt lgkmcnt(0)
    v_and_b32 v174, 0x7fc, v179
    ds_read_b32 v175, v174 offset:16384
L_rsw:
    s_waitcnt lgkmcnt(0)
    v_readfirstlane_b32 s31, v175
    s_cmp_lg_u32 s31, -1
    s_cbranch_scc1 L_rkw
    ds_read_b32 v175, v174 offset:16384
    s_sub_u32 s77, s77, 1
    s_cbranch_scc1 L_end
    s_branch L_rsw
L_rkw:
    s_waitcnt vmcnt(0)
    s_branch L_loop
L_vf0:
    s_waitcnt lgkmcnt(0)
    v_and_b32 v174, 0x7fc, v179
    ds_read_b32 v175, v174 offset:16384
L_rsv0:
    s_waitcnt lgkmcnt(0)
    v_readfirstlane_b32 s31, v175
    s_cmp_lg_u32 s31, -1
    s_cbranch_scc1 L_rkv0
    ds_read_b32 v175, v174 offset:16384
    s_sub_u32 s77, s77, 1
    s_cbranch_scc1 L_end
    s_branch L_rsv0
L_rkv0:
    s_mov_b32 s14, s31
    s_cmp_lg_u32 s31, -2
    s_cbranch_scc1 L_vg0
    s_waitcnt vmcnt(0)
    s_branch L_vh0
L_vg0:
    buffer_load_dwordx4 v[212:215], v2, s[32:35], s14 offen offset:0 nt
    buffer_load_dwordx4 v[216:219], v2, s[32:35], s14 offen offset:1024 nt
    buffer_load_dwordx4 v[220:223], v2, s[32:35], s14 offen offset:2048 nt
    buffer_load_dwordx4 v[224:227], v2, s[32:35], s14 offen offset:3072 nt
L_vh0:
    v_add_u32 v174, s67, v33
    ds_read_b32 v172, v174
    s_waitcnt lgkmcnt(0)
    v_lshlrev_b32 v164, 16, v172
    v_and_b32 v165, s51, v172
    v_fma_f32 v164, v164, s54, -v20
    v_fma_f32 v165, v165, s54, -v20
    v_exp_f32 v164, v164
    v_exp_f32 v165, v165
    s_nop 0
    v_cvt_pk_bf16_f32 v168, v164, v164
    v_cvt_pk_bf16_f32 v169, v165, v165
    v_add_f32 v21, v21, v164
    v_add_f32 v21, v21, v165
    v_and_b32 v180, v168, v12
    v_and_b32 v181, v168, v13
    v_and_b32_dpp v182, v168, v14 row_half_mirror row_mask:0xf bank_mask:0xf
    v_and_b32_dpp v183, v168, v15 row_half_mirror row_mask:0xf bank_mask:0xf
    v_and_b32_dpp v184, v168, v12 row_half_mirror row_mask:0xf bank_mask:0xf
    v_and_b32_dpp v185, v168, v13 row_half_mirror row_mask:0xf bank_mask:0xf
    v_and_b32 v186, v168, v14
    v_and_b32 v187, v168, v15
    v_and_b32 v188, v169, v12
    v_and_b32 v189, v169, v13
    v_and_b32_dpp v190, v169, v14 row_half_mirror row_mask:0xf bank_mask:0xf
    v_and_b32_dpp v191, v169, v15 row_half_mirror row_mask:0xf bank_mask:0xf
    v_and_b32_dpp v192, v169, v12 row_half_mirror row_mask:0xf bank_mask:0xf
    v_and_b32_dpp v193, v169, v13 row_half_mirror row_mask:0xf bank_mask:0xf
    v_and_b32 v194, v169, v14
    v_and_b32 v195, v169, v15
    s_waitcnt vmcnt(7)
    v_mfma_f32_16x16x32_bf16 v[16:19], v[228:231], v[180:183], v[16:19]
    s_waitcnt vmcnt(6)
    v_mfma_f32_16x16x32_bf16 v[16:19], v[232:235], v[184:187], v[16:19]
    s_waitcnt vmcnt(5)
    v_mfma_f32_16x16x32_bf16 v[16:19], v[236:239], v[188:191], v[16:19]
    s_waitcnt vmcnt(4)
    v_mfma_f32_16x16x32_bf16 v[16:19], v[240:243], v[192:195], v[16:19]
    s_cmp_eq_u32 s31, -2
    s_cbranch_scc1 L_fw
L_vref:
    buffer_load_dwordx4 v[228:231], v3, s[36:39], s14 offen offset:0 nt
    buffer_load_dwordx4 v[232:235], v3, s[36:39], s14 offen offset:1024 nt
    buffer_load_dwordx4 v[236:239], v3, s[36:39], s14 offen offset:2048 nt
    buffer_load_dwordx4 v[240:243], v3, s[36:39], s14 offen offset:3072 nt
    s_mov_b64 exec, 1
    ds_add_rtn_u32 v179, v27, v25 offset:780
    s_mov_b64 exec, -1
    s_waitcnt lgkmcnt(0)
    v_and_b32 v174, 0x7fc, v179
    ds_read_b32 v175, v174 offset:16384
L_rsb:
    s_waitcnt lgkmcnt(0)
    v_readfirstlane_b32 s31, v175
    s_cmp_lg_u32 s31, -1
    s_cbranch_scc1 L_rkb
    ds_read_b32 v175, v174 offset:16384
    s_sub_u32 s77, s77, 1
    s_cbranch_scc1 L_end
    s_branch L_rsb
L_rkb:
L_loop:
    s_waitcnt vmcnt(4)
    v_mfma_f32_16x16x32_bf16 v[196:199], v[212:215], v[4:7], 0
    v_mfma_f32_16x16x32_bf16 v[200:203], v[220:223], v[4:7], 0
    v_mfma_f32_16x16x32_bf16 v[196:199], v[216:219], v[8:11], v[196:199]
    v_mfma_f32_16x16x32_bf16 v[200:203], v[224:227], v[8:11], v[200:203]
    s_mov_b32 s14, s31
    s_cmp_eq_u32 s31, -2
    s_cbranch_scc1 L_sm
    buffer_load_dwordx4 v[212:215], v2, s[32:35], s14 offen offset:0 nt
    buffer_load_dwordx4 v[216:219], v2, s[32:35], s14 offen offset:1024 nt
    buffer_load_dwordx4 v[220:223], v2, s[32:35], s14 offen offset:2048 nt
    buffer_load_dwordx4 v[224:227], v2, s[32:35], s14 offen offset:3072 nt
L_sm:
    s_nop 4
    v_mov_b32_dpp v164, v196 quad_perm:[0,0,0,0] row_mask:0xf bank_mask:0xf
    v_mov_b32_dpp v165, v200 quad_perm:[0,0,0,0] row_mask:0xf bank_mask:0xf
    v_mov_b32_dpp v166, v198 quad_perm:[2,2,2,2] row_mask:0xf bank_mask:0xf
    v_mov_b32_dpp v167, v202 quad_perm:[2,2,2,2] row_mask:0xf bank_mask:0xf
    v_add_f32_dpp v164, v197, v164 quad_perm:[1,1,1,1] row_mask:0xf bank_mask:0xf
    v_add_f32_dpp v165, v201, v165 quad_perm:[1,1,1,1] row_mask:0xf bank_mask:0xf
    v_add_f32_dpp v166, v199, v166 quad_perm:[3,3,3,3] row_mask:0xf bank_mask:0xf
    v_add_f32_dpp v167, v203, v167 quad_perm:[3,3,3,3] row_mask:0xf bank_mask:0xf
    v_pk_add_f32 v[164:165], v[164:165], v[166:167]
    v_cvt_pk_bf16_f32 v172, v164, v165
    v_lshlrev_b32 v164, 16, v172
    v_and_b32 v165, s51, v172
    v_pk_mul_f32 v[164:165], v[164:165], s[52:53]
    v_cvt_pk_bf16_f32 v172, v164, v165
    v_lshlrev_b32 v164, 16, v172
    v_and_b32 v165, s51, v172
    v_max_f32 v176, v164, v165
    s_nop 1
    v_max_f32_dpp v176, v176, v176 row_half_mirror row_mask:0xf bank_mask:0xf
    v_mov_b32 v177, v176
    s_nop 1
    v_permlane16_swap_b32 v176, v177
    s_nop 0
    v_max_f32 v176, v176, v177
    v_mov_b32 v177, v176
    s_nop 1
    v_permlane32_swap_b32 v176, v177
    s_nop 0
    v_max_f32 v176, v176, v177
    v_mul_f32 v176, s54, v176
    v_max_f32 v176, v176, v20
    v_sub_f32 v178, v20, v176
    v_mov_b32 v20, v176
    v_exp_f32 v178, v178
    v_fma_f32 v164, v164, s54, -v176
    v_fma_f32 v165, v165, s54, -v176
    v_exp_f32 v164, v164
    v_exp_f32 v165, v165
    v_mul_f32 v16, v16, v178
    v_mul_f32 v17, v17, v178
    v_mul_f32 v18, v18, v178
    v_mul_f32 v19, v19, v178
    v_cvt_pk_bf16_f32 v168, v164, v164
    v_cvt_pk_bf16_f32 v169, v165, v165
    v_fma_f32 v21, v21, v178, v164
    v_add_f32 v21, v21, v165
    v_and_b32 v180, v168, v12
    v_and_b32 v181, v168, v13
    v_and_b32_dpp v182, v168, v14 row_half_mirror row_mask:0xf bank_mask:0xf
    v_and_b32_dpp v183, v168, v15 row_half_mirror row_mask:0xf bank_mask:0xf
    v_and_b32_dpp v184, v168, v12 row_half_mirror row_mask:0xf bank_mask:0xf
    v_and_b32_dpp v185, v168, v13 row_half_mirror row_mask:0xf bank_mask:0xf
    v_and_b32 v186, v168, v14
    v_and_b32 v187, v168, v15
    v_and_b32 v188, v169, v12
    v_and_b32 v189, v169, v13
    v_and_b32_dpp v190, v169, v14 row_half_mirror row_mask:0xf bank_mask:0xf
    v_and_b32_dpp v191, v169, v15 row_half_mirror row_mask:0xf bank_mask:0xf
    v_and_b32_dpp v192, v169, v12 row_half_mirror row_mask:0xf bank_mask:0xf
    v_and_b32_dpp v193, v169, v13 row_half_mirror row_mask:0xf bank_mask:0xf
    v_and_b32 v194, v169, v14
    v_and_b32 v195, v169, v15
    s_cmp_eq_u32 s31, -2
    s_cbranch_scc1 L_pvl
    s_waitcnt vmcnt(7)
    v_mfma_f32_16x16x32_bf16 v[16:19], v[228:231], v[180:183], v[16:19]
    s_waitcnt vmcnt(6)
    v_mfma_f32_16x16x32_bf16 v[16:19], v[232:235], v[184:187], v[16:19]
    s_waitcnt vmcnt(5)
    v_mfma_f32_16x16x32_bf16 v[16:19], v[236:239], v[188:191], v[16:19]
    s_waitcnt vmcnt(4)
    v_mfma_f32_16x16x32_bf16 v[16:19], v[240:243], v[192:195], v[16:19]
    s_branch L_vref
L_fw:
    v_add_f32_dpp v21, v21, v21 row_half_mirror row_mask:0xf bank_mask:0xf
    v_mov_b32 v164, v21
    s_nop 1
    v_permlane16_swap_b32 v21, v164
    s_nop 0
    v_add_f32 v21, v21, v164
    v_mov_b32 v164, v21
    s_nop 1
    v_permlane32_swap_b32 v21, v164
    s_nop 0
    v_add_f32 v21, v21, v164
    v_lshlrev_b32 v165, 4, v0
    ds_write_b64 v28, v[20:21] offset:512
    s_branch L_pw
L_pvl:
    v_add_f32_dpp v21, v21, v21 row_half_mirror row_mask:0xf bank_mask:0xf
    v_mov_b32 v164, v21
    s_nop 1
    v_permlane16_swap_b32 v21, v164
    s_nop 0
    v_add_f32 v21, v21, v164
    v_mov_b32 v164, v21
    s_nop 1
    v_permlane32_swap_b32 v21, v164
    s_nop 0
    v_add_f32 v21, v21, v164
    v_lshlrev_b32 v165, 4, v0
    ds_write_b64 v28, v[20:21] offset:512
    s_waitcnt vmcnt(3)
    v_mfma_f32_16x16x32_bf16 v[16:19], v[228:231], v[180:183], v[16:19]
    s_waitcnt vmcnt(2)
    v_mfma_f32_16x16x32_bf16 v[16:19], v[232:235], v[184:187], v[16:19]
    s_waitcnt vmcnt(1)
    v_mfma_f32_16x16x32_bf16 v[16:19], v[236:239], v[188:191], v[16:19]
    s_waitcnt vmcnt(0)
    v_mfma_f32_16x16x32_bf16 v[16:19], v[240:243], v[192:195], v[16:19]
    s_nop 7
L_pw:
    ds_write_b128 v165, v[16:19] offset:1024
    s_mov_b64 exec, 1
    ds_add_u32 v27, v26 offset:800
    s_mov_b64 exec, -1
    s_cmp_lt_u32 s3, 4
    s_cbranch_scc1 L_t1
    s_cmp_ge_u32 s78, 9
    s_cbranch_scc1 L_t3
    global_load_lds_dwordx4 v30, s[12:13] nt
    s_add_u32 m0, m0, 1024
    v_add_u32 v30, 9216, v30
    global_load_lds_dwordx4 v30, s[12:13] nt
    s_add_u32 m0, m0, 1024
    v_add_u32 v30, 9216, v30
    global_load_lds_dwordx4 v30, s[12:13] nt
    s_add_u32 m0, m0, 1024
    v_add_u32 v30, 9216, v30
    global_load_lds_dwordx4 v30, s[12:13] nt
    s_add_u32 m0, m0, 1024
    v_add_u32 v30, 9216, v30
    global_load_lds_dwordx4 v30, s[12:13] nt
    s_add_u32 m0, m0, 1024
    v_add_u32 v30, 9216, v30
    global_load_lds_dwordx4 v30, s[12:13] nt
    s_add_u32 m0, m0, 1024
    v_add_u32 v30, 9216, v30
    global_load_lds_dwordx4 v30, s[12:13] nt
    s_add_u32 m0, m0, 1024
    v_add_u32 v30, 9216, v30
    global_load_lds_dwordx4 v30, s[12:13] nt
L_t2:
    s_bfe_u32 s57, s3, 0x10001
    s_lshl1_add_u32 s56, s55, s57
    s_mul_i32 s56, s56, 5120
    s_add_u32 s56, s56, 592384
    v_lshrrev_b32 v169, 4, v1
    v_and_b32 v170, 15, v1
    v_mul_u32_u24 v68, 640, v169
    v_lshl_add_u32 v68, v170, 4, v68
    s_and_b32 s57, s3, 1
    s_lshl_b32 s57, s57, 8
    s_add_u32 s57, s57, s56
    v_add_u32 v68, s57, v68
    v_add_u32 v69, 163840, v68
    v_xor_b32 v169, v169, v170
    v_and_b32 v70, 7, v169
    v_mul_u32_u24 v70, 640, v70
    v_lshrrev_b32 v169, 3, v169
    v_mul_u32_u24 v169, 163840, v169
    v_add3_u32 v70, v70, v169, s56
    v_lshlrev_b32 v169, 2, v170
    v_alignbit_b32 v169, s50, s50, v169
    v_xor_b32 v79, s50, v170
    v_bfi_b32 v79, 1, v79, v169
    v_lshrrev_b32 v74, 4, v1
    v_lshlrev_b32 v72, 3, v74
    v_bfe_u32 v169, v1, 2, 2
    v_add_lshl_u32 v72, v72, v169, 7
    v_and_b32 v169, 3, v1
    v_lshl_add_u32 v72, v169, 3, v72
    s_and_b32 s57, s3, 3
    s_lshl_b32 s56, s57, 13
    v_add_u32 v72, s56, v72
    s_lshl_b32 s56, s57, 8
    v_and_b32 v169, 15, v1
    v_lshl_add_u32 v169, v169, 2, v74
    v_lshl_add_u32 v73, v169, 1, s56
    v_lshl_add_u32 v74, v74, 4, s56
    v_and_b32 v169, 1, v1
    v_lshl_add_u32 v74, v169, 7, v74
    s_lshl_b32 s56, s57, 2
    v_add_u32 v75, s56, v3
    s_mul_i32 s56, s55, 2304
    s_lshl_b32 s57, s78, 8
    s_add_u32 s56, s56, s57
    s_add_u32 s56, s56, 917504
    v_lshl_add_u32 v76, v1, 2, s56
    v_add_u32 v77, 36864, v76
    v_and_b32 v170, 16, v1
    v_cmp_eq_u32 s[62:63], 0, v170
    v_cmp_gt_u32 s[60:61], 32, v1
L_wda:
    ds_read_b32 v164, v27 offset:800
    s_waitcnt lgkmcnt(0)
    v_cmp_ne_u32 vcc, 8, v164
    s_sub_u32 s77, s77, 1
    s_cbranch_scc1 L_end
    s_cbranch_vccnz L_wda
    s_waitcnt vmcnt(0)
    s_cbranch_execz L_sk1
    global_load_dwordx3 v[188:190], v70, s[28:29] offset:-2048 sc1
    global_load_dwordx4 v[172:175], v68, s[28:29] offset:-2560 sc1
    global_load_dwordx4 v[176:179], v68, s[28:29] offset:0 sc1
    global_load_dwordx4 v[180:183], v69, s[28:29] offset:-2560 sc1
    global_load_dwordx4 v[184:187], v69, s[28:29] offset:0 sc1
L_sk1:
    s_waitcnt vmcnt(5)
    ds_read_b64_tr_b16 v[36:37], v72 offset:33792
    ds_read_b64_tr_b16 v[38:39], v72 offset:34304
    ds_read_b64_tr_b16 v[40:41], v72 offset:33824
    ds_read_b64_tr_b16 v[42:43], v72 offset:34336
    ds_read_b64_tr_b16 v[44:45], v72 offset:33856
    ds_read_b64_tr_b16 v[46:47], v72 offset:34368
    ds_read_b64_tr_b16 v[48:49], v72 offset:33888
    ds_read_b64_tr_b16 v[50:51], v72 offset:34400
    ds_read_b64_tr_b16 v[52:53], v72 offset:37888
    ds_read_b64_tr_b16 v[54:55], v72 offset:38400
    ds_read_b64_tr_b16 v[56:57], v72 offset:37920
    ds_read_b64_tr_b16 v[58:59], v72 offset:38432
    ds_read_b64_tr_b16 v[60:61], v72 offset:37952
    ds_read_b64_tr_b16 v[62:63], v72 offset:38464
    ds_read_b64_tr_b16 v[64:65], v72 offset:37984
    ds_read_b64_tr_b16 v[66:67], v72 offset:38496
    s_branch L_g1c
L_g1poll:
    global_load_dwordx3 v[188:190], v70, s[28:29] offset:-2048 sc1
    global_load_dwordx4 v[172:175], v68, s[28:29] offset:-2560 sc1
    global_load_dwordx4 v[176:179], v68, s[28:29] offset:0 sc1
    global_load_dwordx4 v[180:183], v69, s[28:29] offset:-2560 sc1
    global_load_dwordx4 v[184:187], v69, s[28:29] offset:0 sc1
L_g1c:
    s_sub_u32 s77, s77, 16
    s_cbranch_scc1 L_end
    s_waitcnt vmcnt(0)
    v_xor_b32 v166, v172, v79
    v_xor_b32 v167, v176, v79
    v_bitop3_b32 v166, v166, v180, v79 bitop3:0xf6
    v_bitop3_b32 v167, v167, v184, v79 bitop3:0xf6
    v_bitop3_b32 v166, v166, v167, 63 bitop3:0xa8
    v_bitop3_b32 v166, v166, v190, s50 bitop3:0xf6
    v_cmp_ne_u32 vcc, 0, v166
    s_cbranch_vccnz L_g1poll
    v_max_f32_dpp v190, v188, v188 quad_perm:[1,0,3,2] row_mask:0xf bank_mask:0xf
    s_nop 1
    v_max_f32_dpp v190, v190, v190 quad_perm:[2,3,0,1] row_mask:0xf bank_mask:0xf
    s_nop 1
    v_max_f32_dpp v190, v190, v190 row_half_mirror row_mask:0xf bank_mask:0xf
    v_sub_f32 v191, v188, v190
    v_exp_f32 v191, v191
    s_nop 0
    v_mul_f32 v189, v189, v191
    s_nop 0
    v_mul_f32_dpp v192, v191, v172 row_newbcast:0 row_mask:0xf bank_mask:0xf
    v_add_f32_dpp v189, v189, v189 quad_perm:[1,0,3,2] row_mask:0xf bank_mask:0xf
    v_mul_f32_dpp v193, v191, v173 row_newbcast:0 row_mask:0xf bank_mask:0xf
    v_mul_f32_dpp v194, v191, v174 row_newbcast:0 row_mask:0xf bank_mask:0xf
    v_mul_f32_dpp v195, v191, v175 row_newbcast:0 row_mask:0xf bank_mask:0xf
    v_add_f32_dpp v189, v189, v189 quad_perm:[2,3,0,1] row_mask:0xf bank_mask:0xf
    v_mul_f32_dpp v196, v191, v180 row_newbcast:8 row_mask:0xf bank_mask:0xf
    v_mul_f32_dpp v197, v191, v181 row_newbcast:8 row_mask:0xf bank_mask:0xf
    v_mul_f32_dpp v198, v191, v182 row_newbcast:8 row_mask:0xf bank_mask:0xf
    v_add_f32_dpp v189, v189, v189 row_half_mirror row_mask:0xf bank_mask:0xf
    v_mul_f32_dpp v199, v191, v183 row_newbcast:8 row_mask:0xf bank_mask:0xf
    v_fmac_f32_dpp v192, v191, v176 row_newbcast:4 row_mask:0xf bank_mask:0xf
    v_rcp_f32 v188, v189
    v_fmac_f32_dpp v193, v191, v177 row_newbcast:4 row_mask:0xf bank_mask:0xf
    v_fmac_f32_dpp v194, v191, v178 row_newbcast:4 row_mask:0xf bank_mask:0xf
    v_fmac_f32_dpp v195, v191, v179 row_newbcast:4 row_mask:0xf bank_mask:0xf
    v_fmac_f32_dpp v196, v191, v184 row_newbcast:12 row_mask:0xf bank_mask:0xf
    v_fmac_f32_dpp v197, v191, v185 row_newbcast:12 row_mask:0xf bank_mask:0xf
    v_fmac_f32_dpp v198, v191, v186 row_newbcast:12 row_mask:0xf bank_mask:0xf
    v_fmac_f32_dpp v199, v191, v187 row_newbcast:12 row_mask:0xf bank_mask:0xf
    v_permlane16_swap_b32 v192, v193
    v_permlane16_swap_b32 v194, v195
    s_nop 0
    v_permlane16_swap_b32 v196, v197
    v_permlane16_swap_b32 v198, v199
    v_add_f32 v192, v192, v193
    v_add_f32 v194, v194, v195
    v_add_f32 v196, v196, v197
    v_add_f32 v198, v198, v199
    s_nop 0
    v_permlane32_swap_b32 v192, v194
    v_permlane32_swap_b32 v196, v198
    s_nop 0
    v_add_f32 v192, v192, v194
    v_add_f32 v196, v196, v198
    s_nop 0
    v_mul_f32_dpp v192, v188, v192 row_newbcast:0 row_mask:0xf bank_mask:0xf
    v_mul_f32_dpp v196, v188, v196 row_newbcast:8 row_mask:0xf bank_mask:0xf
    v_cvt_pk_bf16_f32 v166, v192, v196
    ds_write_b16 v73, v166 offset:9216
    ds_write_b16_d16_hi v73, v166 offset:9344
    ds_read_b128 v[200:203], v74 offset:9216
    ds_read_b128 v[204:207], v74 offset:9280
    v_xor_b32 v168, v173, v79
    v_xor_b32 v169, v174, v79
    v_bitop3_b32 v168, v168, v175, v79 bitop3:0xf6
    v_bitop3_b32 v169, v169, v177, v79 bitop3:0xf6
    v_bitop3_b32 v168, v168, v178, v79 bitop3:0xf6
    v_bitop3_b32 v169, v169, v179, v79 bitop3:0xf6
    v_bitop3_b32 v168, v168, v181, v79 bitop3:0xf6
    v_bitop3_b32 v169, v169, v182, v79 bitop3:0xf6
    v_bitop3_b32 v168, v168, v183, v79 bitop3:0xf6
    v_bitop3_b32 v169, v169, v185, v79 bitop3:0xf6
    v_bitop3_b32 v168, v168, v186, v79 bitop3:0xf6
    v_bitop3_b32 v169, v169, v187, v79 bitop3:0xf6
    v_bitop3_b32 v168, v168, v169, 63 bitop3:0xa8
    v_cmp_ne_u32 vcc, 0, v168
    s_cbranch_vccnz L_g1poll
    s_waitcnt lgkmcnt(1)
    v_mfma_f32_16x16x32_bf16 v[208:211], v[200:203], v[36:39], 0
    v_mfma_f32_16x16x32_bf16 v[212:215], v[200:203], v[40:43], 0
    v_mfma_f32_16x16x32_bf16 v[216:219], v[200:203], v[44:47], 0
    v_mfma_f32_16x16x32_bf16 v[220:223], v[200:203], v[48:51], 0
    s_waitcnt lgkmcnt(0)
    v_mfma_f32_16x16x32_bf16 v[208:211], v[204:207], v[52:55], v[208:211]
    v_mfma_f32_16x16x32_bf16 v[212:215], v[204:207], v[56:59], v[212:215]
    v_mfma_f32_16x16x32_bf16 v[216:219], v[204:207], v[60:63], v[216:219]
    v_mfma_f32_16x16x32_bf16 v[220:223], v[204:207], v[64:67], v[220:223]
    s_nop 5
    v_cndmask_b32 v166, v212, v208, s[62:63]
    v_cndmask_b32 v167, v213, v209, s[62:63]
    v_cndmask_b32 v168, v220, v216, s[62:63]
    v_cndmask_b32 v169, v221, v217, s[62:63]
    v_cndmask_b32 v166, v168, v166, s[60:61]
    v_cndmask_b32 v167, v169, v167, s[60:61]
    ds_write2st64_b32 v75, v166, v167 offset0:40 offset1:44
    s_cbranch_execz L_sk2
    s_mov_b64 exec, 1
    ds_add_rtn_u32 v170, v27, v26 offset:804
    s_mov_b64 exec, -1
L_sk2:
    ds_read_b128 v[200:203], v3 offset:10240
    ds_read_b128 v[204:207], v3 offset:11264
    s_waitcnt lgkmcnt(0)
    v_readfirstlane_b32 s56, v170
    v_pk_add_f32 v[200:201], v[200:201], v[202:203]
    v_pk_add_f32 v[204:205], v[204:205], v[206:207]
    s_cmp_lg_u32 s56, 3
    s_cbranch_scc1 L_fin
    v_add_f32 v200, v200, v201
    v_add_f32 v204, v204, v205
    v_bfi_b32 v200, 63, v31, v200
    v_bfi_b32 v204, 63, v31, v204
    s_cbranch_execz L_sk3
    global_store_dword v76, v200, s[28:29] sc1
    global_store_dword v77, v204, s[28:29] sc1
L_sk3:
    s_branch L_fin
L_t1:
L_wdb:
    ds_read_b32 v164, v27 offset:800
    s_waitcnt lgkmcnt(0)
    v_cmp_ne_u32 vcc, 8, v164
    s_sub_u32 s77, s77, 1
    s_cbranch_scc1 L_end
    s_cbranch_vccnz L_wdb
    ds_read_b64 v[196:197], v157 offset:512
    ds_read2st64_b32 v[188:189], v156 offset0:0 offset1:4
    ds_read2st64_b32 v[190:191], v156 offset0:8 offset1:12
    ds_read2st64_b32 v[192:193], v156 offset0:16 offset1:20
    ds_read2st64_b32 v[194:195], v156 offset0:24 offset1:28
    s_waitcnt lgkmcnt(0)
    v_max_f32_dpp v198, v196, v196 quad_perm:[1,0,3,2] row_mask:0xf bank_mask:0xf
    s_nop 1
    v_max_f32_dpp v198, v198, v198 quad_perm:[2,3,0,1] row_mask:0xf bank_mask:0xf
    s_nop 1
    v_max_f32_dpp v198, v198, v198 row_half_mirror row_mask:0xf bank_mask:0xf
    v_sub_f32 v199, v196, v198
    v_exp_f32 v199, v199
    v_mov_b32 v196, v198
    v_mul_f32 v197, v197, v199
    s_nop 0
    v_mul_f32_dpp v200, v199, v188 row_newbcast:0 row_mask:0xf bank_mask:0xf
    v_add_f32_dpp v197, v197, v197 quad_perm:[1,0,3,2] row_mask:0xf bank_mask:0xf
    v_mul_f32_dpp v201, v199, v189 row_newbcast:1 row_mask:0xf bank_mask:0xf
    v_mul_f32_dpp v202, v199, v190 row_newbcast:2 row_mask:0xf bank_mask:0xf
    v_fmac_f32_dpp v200, v199, v191 row_newbcast:3 row_mask:0xf bank_mask:0xf
    v_add_f32_dpp v197, v197, v197 quad_perm:[2,3,0,1] row_mask:0xf bank_mask:0xf
    v_fmac_f32_dpp v201, v199, v192 row_newbcast:4 row_mask:0xf bank_mask:0xf
    v_fmac_f32_dpp v202, v199, v193 row_newbcast:5 row_mask:0xf bank_mask:0xf
    v_fmac_f32_dpp v200, v199, v194 row_newbcast:6 row_mask:0xf bank_mask:0xf
    v_add_f32_dpp v197, v197, v197 row_half_mirror row_mask:0xf bank_mask:0xf
    v_fmac_f32_dpp v201, v199, v195 row_newbcast:7 row_mask:0xf bank_mask:0xf
    v_add_f32 v200, v200, v202
    v_add_f32 v200, v200, v201
    v_bfi_b32 v200, 63, v31, v200
    v_mov_b32 v198, s50
    s_cbranch_execz L_sk4
    global_store_dword v158, v200, s[28:29] sc1
    s_bitcmp1_b32 s3, 0
    s_cbranch_scc1 L_nml
    global_store_dwordx3 v159, v[196:198], s[28:29] offset:512 sc1
L_nml:
L_sk4:
L_t3:
    s_and_b32 s56, s2, 127
    s_cmp_lg_u32 s56, 7
    s_cbranch_scc1 L_fin
    s_lshr_b32 s58, s2, 7
    s_cmp_eq_u32 s3, 0
    s_cbranch_scc1 L_w0fin
    s_cmp_ge_u32 s3, 6
    s_cbranch_scc1 L_fin
    s_mul_i32 s56, s58, 36864
    s_add_u32 s56, s56, 917504
    v_lshrrev_b32 v169, 4, v1
    v_mul_u32_u24 v164, 2304, v169
    v_lshl_add_u32 v164, v29, 2, v164
    v_add_u32 v164, s56, v164
    v_add_u32 v165, 9216, v164
    v_add_u32 v166, 18432, v164
    v_add_u32 v167, 27648, v164
    v_add_lshl_u32 v168, v169, v29, 2
    v_and_b32 v170, 15, v1
    v_lshlrev_b32 v171, 2, v170
    v_alignbit_b32 v171, s50, s50, v171
    v_xor_b32 v169, s50, v170
    v_bfi_b32 v169, 1, v169, v171
    v_lshlrev_b32 v170, 16, v22
    v_lshlrev_b32 v171, 16, v23
L_g2poll:
    s_cbranch_execz L_sk5
    global_load_dwordx4 v[36:39], v164, s[28:29] offset:0 sc1
    global_load_dwordx4 v[40:43], v165, s[28:29] offset:0 sc1
    global_load_dwordx4 v[44:47], v166, s[28:29] offset:0 sc1
    global_load_dwordx4 v[48:51], v167, s[28:29] offset:0 sc1
    global_load_dwordx4 v[52:55], v164, s[28:29] offset:256 sc1
    global_load_dwordx4 v[56:59], v165, s[28:29] offset:256 sc1
    global_load_dwordx4 v[60:63], v166, s[28:29] offset:256 sc1
    global_load_dwordx4 v[64:67], v167, s[28:29] offset:256 sc1
    s_sub_u32 s77, s77, 16
    s_cbranch_scc1 L_end
    s_waitcnt vmcnt(0)
L_sk5:
    v_xor_b32 v172, v36, v169
    v_xor_b32 v173, v40, v169
    v_bitop3_b32 v172, v172, v44, v169 bitop3:0xf6
    v_bitop3_b32 v173, v173, v48, v169 bitop3:0xf6
    v_bitop3_b32 v172, v172, v52, v169 bitop3:0xf6
    v_bitop3_b32 v173, v173, v56, v169 bitop3:0xf6
    v_bitop3_b32 v172, v172, v60, v169 bitop3:0xf6
    v_bitop3_b32 v173, v173, v64, v169 bitop3:0xf6
    v_bitop3_b32 v172, v172, v173, 63 bitop3:0xa8
    v_cmp_ne_u32 vcc, 0, v172
    s_cbranch_vccnz L_g2poll
    v_pk_add_f32 v[172:173], v[36:37], v[40:41]
    v_pk_add_f32 v[176:177], v[44:45], v[48:49]
    v_pk_add_f32 v[174:175], v[38:39], v[42:43]
    v_pk_add_f32 v[178:179], v[46:47], v[50:51]
    v_pk_add_f32 v[180:181], v[52:53], v[56:57]
    v_pk_add_f32 v[184:185], v[60:61], v[64:65]
    v_pk_add_f32 v[182:183], v[54:55], v[58:59]
    v_pk_add_f32 v[186:187], v[62:63], v[66:67]
    v_pk_add_f32 v[172:173], v[172:173], v[176:177]
    v_pk_add_f32 v[174:175], v[174:175], v[178:179]
    v_pk_add_f32 v[180:181], v[180:181], v[184:185]
    v_pk_add_f32 v[182:183], v[182:183], v[186:187]
    s_nop 0
    v_permlane16_swap_b32 v172, v173
    v_permlane16_swap_b32 v174, v175
    v_permlane16_swap_b32 v180, v181
    v_permlane16_swap_b32 v182, v183
    v_add_f32 v172, v172, v173
    v_add_f32 v174, v174, v175
    v_add_f32 v180, v180, v181
    v_add_f32 v182, v182, v183
    s_nop 0
    v_permlane32_swap_b32 v172, v174
    v_permlane32_swap_b32 v180, v182
    s_nop 0
    v_add_f32 v188, v172, v174
    v_add_f32 v189, v180, v182
    v_cvt_pk_bf16_f32 v190, v188, v189
    v_lshlrev_b32 v188, 16, v190
    v_and_b32 v189, s51, v190
    v_pk_add_f32 v[188:189], v[188:189], v[170:171]
    v_cvt_pk_bf16_f32 v190, v188, v189
    v_lshlrev_b32 v188, 16, v190
    v_and_b32 v189, s51, v190
    ds_write2st64_b32 v168, v188, v189 offset0:48 offset1:49
    v_xor_b32 v172, v37, v169
    v_xor_b32 v173, v38, v169
    v_bitop3_b32 v172, v172, v39, v169 bitop3:0xf6
    v_bitop3_b32 v173, v173, v41, v169 bitop3:0xf6
    v_bitop3_b32 v172, v172, v42, v169 bitop3:0xf6
    v_bitop3_b32 v173, v173, v43, v169 bitop3:0xf6
    v_bitop3_b32 v172, v172, v45, v169 bitop3:0xf6
    v_bitop3_b32 v173, v173, v46, v169 bitop3:0xf6
    v_bitop3_b32 v172, v172, v47, v169 bitop3:0xf6
    v_bitop3_b32 v173, v173, v49, v169 bitop3:0xf6
    v_bitop3_b32 v172, v172, v50, v169 bitop3:0xf6
    v_bitop3_b32 v173, v173, v51, v169 bitop3:0xf6
    v_bitop3_b32 v172, v172, v53, v169 bitop3:0xf6
    v_bitop3_b32 v173, v173, v54, v169 bitop3:0xf6
    v_bitop3_b32 v172, v172, v55, v169 bitop3:0xf6
    v_bitop3_b32 v173, v173, v57, v169 bitop3:0xf6
    v_bitop3_b32 v172, v172, v58, v169 bitop3:0xf6
    v_bitop3_b32 v173, v173, v59, v169 bitop3:0xf6
    v_bitop3_b32 v172, v172, v61, v169 bitop3:0xf6
    v_bitop3_b32 v173, v173, v62, v169 bitop3:0xf6
    v_bitop3_b32 v172, v172, v63, v169 bitop3:0xf6
    v_bitop3_b32 v173, v173, v65, v169 bitop3:0xf6
    v_bitop3_b32 v172, v172, v66, v169 bitop3:0xf6
    v_bitop3_b32 v173, v173, v67, v169 bitop3:0xf6
    v_bitop3_b32 v172, v172, v173, 63 bitop3:0xa8
    v_cmp_ne_u32 vcc, 0, v172
    s_cbranch_vccnz L_g2poll
    s_cbranch_execz L_sk6
    s_waitcnt lgkmcnt(0)
    s_barrier
L_sk6:
    s_branch L_fin
L_w0fin:
    s_cbranch_execz L_ng
    v_lshrrev_b32 v166, 2, v1
    v_lshlrev_b32 v166, 8, v166
    v_and_b32 v167, 3, v1
    v_lshl_add_u32 v166, v167, 4, v166
    v_add_u32 v172, 1052864, v166
    v_add_u32 v173, 1061056, v166
    v_add_u32 v174, 1069248, v166
    v_add_u32 v175, 1077440, v166
    v_add_u32 v176, 1085632, v166
    v_add_u32 v177, 1093824, v166
    v_add_u32 v178, 1102016, v166
    v_add_u32 v179, 1110208, v166
L_tpoll:
    global_load_dwordx4 v[36:39], v172, s[28:29] offset:-4096 sc1
    global_load_dwordx4 v[40:43], v172, s[28:29] offset:0 sc1
    global_load_dwordx4 v[44:47], v173, s[28:29] offset:-4096 sc1
    global_load_dwordx4 v[48:51], v173, s[28:29] offset:0 sc1
    global_load_dwordx4 v[52:55], v174, s[28:29] offset:-4096 sc1
    global_load_dwordx4 v[56:59], v174, s[28:29] offset:0 sc1
    global_load_dwordx4 v[60:63], v175, s[28:29] offset:-4096 sc1
    global_load_dwordx4 v[64:67], v175, s[28:29] offset:0 sc1
    global_load_dwordx4 v[68:71], v176, s[28:29] offset:-4096 sc1
    global_load_dwordx4 v[72:75], v176, s[28:29] offset:0 sc1
    global_load_dwordx4 v[76:79], v177, s[28:29] offset:-4096 sc1
    global_load_dwordx4 v[80:83], v177, s[28:29] offset:0 sc1
    global_load_dwordx4 v[84:87], v178, s[28:29] offset:-4096 sc1
    global_load_dwordx4 v[88:91], v178, s[28:29] offset:0 sc1
    global_load_dwordx4 v[92:95], v179, s[28:29] offset:-4096 sc1
    global_load_dwordx4 v[96:99], v179, s[28:29] offset:0 sc1
    v_mov_b32 v168, s50
    v_mov_b32 v169, s50
    s_waitcnt vmcnt(0)
    v_max3_u32 v168, v168, v39, v43
    v_min3_u32 v169, v169, v39, v43
    v_max3_u32 v168, v168, v47, v51
    v_min3_u32 v169, v169, v47, v51
    v_max3_u32 v168, v168, v55, v59
    v_min3_u32 v169, v169, v55, v59
    v_max3_u32 v168, v168, v63, v67
    v_min3_u32 v169, v169, v63, v67
    v_max3_u32 v168, v168, v71, v75
    v_min3_u32 v169, v169, v71, v75
    v_max3_u32 v168, v168, v79, v83
    v_min3_u32 v169, v169, v79, v83
    v_max3_u32 v168, v168, v87, v91
    v_min3_u32 v169, v169, v87, v91
    v_max3_u32 v168, v168, v95, v99
    v_min3_u32 v169, v169, v95, v99
    v_cmp_ne_u32 vcc, v168, v169
    s_sub_u32 s77, s77, 32
    s_cbranch_scc1 L_end
    s_cbranch_vccnz L_tpoll
    v_mul_u32_u24 v166, 12, v1
    v_add_u32 v167, 0x10000, v166
    ds_write_b32 v166, v36 offset:27648
    ds_write_b32 v166, v37 offset:27652
    ds_write_b32 v166, v38 offset:27656
    ds_write_b32 v166, v40 offset:28416
    ds_write_b32 v166, v41 offset:28420
    ds_write_b32 v166, v42 offset:28424
    ds_write_b32 v166, v44 offset:29184
    ds_write_b32 v166, v45 offset:29188
    ds_write_b32 v166, v46 offset:29192
    ds_write_b32 v166, v48 offset:29952
    ds_write_b32 v166, v49 offset:29956
    ds_write_b32 v166, v50 offset:29960
    ds_write_b32 v166, v52 offset:30720
    ds_write_b32 v166, v53 offset:30724
    ds_write_b32 v166, v54 offset:30728
    ds_write_b32 v166, v56 offset:31488
    ds_write_b32 v166, v57 offset:31492
    ds_write_b32 v166, v58 offset:31496
    ds_write_b32 v166, v60 offset:32256
    ds_write_b32 v166, v61 offset:32260
    ds_write_b32 v166, v62 offset:32264
    ds_write_b32 v166, v64 offset:33024
    ds_write_b32 v166, v65 offset:33028
    ds_write_b32 v166, v66 offset:33032
    ds_write_b32 v167, v68 offset:27648
    ds_write_b32 v167, v69 offset:27652
    ds_write_b32 v167, v70 offset:27656
    ds_write_b32 v167, v72 offset:28416
    ds_write_b32 v167, v73 offset:28420
    ds_write_b32 v167, v74 offset:28424
    ds_write_b32 v167, v76 offset:29184
    ds_write_b32 v167, v77 offset:29188
    ds_write_b32 v167, v78 offset:29192
    ds_write_b32 v167, v80 offset:29952
    ds_write_b32 v167, v81 offset:29956
    ds_write_b32 v167, v82 offset:29960
    ds_write_b32 v167, v84 offset:30720
    ds_write_b32 v167, v85 offset:30724
    ds_write_b32 v167, v86 offset:30728
    ds_write_b32 v167, v88 offset:31488
    ds_write_b32 v167, v89 offset:31492
    ds_write_b32 v167, v90 offset:31496
    ds_write_b32 v167, v92 offset:32256
    ds_write_b32 v167, v93 offset:32260
    ds_write_b32 v167, v94 offset:32264
    ds_write_b32 v167, v96 offset:33024
    ds_write_b32 v167, v97 offset:33028
    ds_write_b32 v167, v98 offset:33032
    global_store_dword v27, v168, s[28:29] offset:0 sc1
L_ng:
    v_lshlrev_b32 v165, 3, v1
    v_lshlrev_b32 v166, 2, v1
    s_mul_i32 s58, s58, 1152
    v_add_u32 v168, s58, v166
    v_lshl_add_u32 v169, v1, 1, s58
    v_mov_b32 v204, 0
    v_mov_b32 v205, 0
    v_mov_b32 v206, 0
    v_mov_b32 v207, 0
    v_mov_b32 v208, 0
    v_mov_b32 v209, 0
    v_mov_b32 v210, 0
    v_mov_b32 v211, 0
    v_mov_b32 v212, 0
    s_mov_b32 s59, 0x3ae38e39
    s_cbranch_execz L_sk7
    s_waitcnt lgkmcnt(0)
    s_barrier
L_sk7:
    ds_read_b32 v224, v27 offset:12288
    ds_read_b64 v[172:173], v165 offset:12288
    ds_read_b64 v[174:175], v165 offset:12800
    ds_read_b64 v[176:177], v165 offset:13312
    ds_read_b64 v[178:179], v165 offset:13824
    ds_read_b32 v180, v166 offset:14336
    s_waitcnt lgkmcnt(0)
    v_pk_add_f32 v[182:183], v[172:173], v[224:225] op_sel_hi:[1,0] neg_lo:[0,1] neg_hi:[0,1]
    v_pk_add_f32 v[184:185], v[174:175], v[224:225] op_sel_hi:[1,0] neg_lo:[0,1] neg_hi:[0,1]
    v_pk_add_f32 v[186:187], v[176:177], v[224:225] op_sel_hi:[1,0] neg_lo:[0,1] neg_hi:[0,1]
    v_pk_add_f32 v[188:189], v[178:179], v[224:225] op_sel_hi:[1,0] neg_lo:[0,1] neg_hi:[0,1]
    v_sub_f32 v190, v180, v224
    v_pk_add_f32 v[226:227], v[182:183], v[184:185]
    v_pk_mul_f32 v[232:233], v[182:183], v[182:183]
    v_pk_add_f32 v[234:235], v[186:187], v[188:189]
    v_pk_fma_f32 v[232:233], v[184:185], v[184:185], v[232:233]
    v_pk_add_f32 v[226:227], v[226:227], v[234:235]
    v_pk_fma_f32 v[232:233], v[186:187], v[186:187], v[232:233]
    v_add_f32 v226, v226, v190
    v_pk_fma_f32 v[232:233], v[188:189], v[188:189], v[232:233]
    v_fmac_f32 v232, v190, v190
    v_add_f32 v226, v226, v227
    v_add_f32 v232, v232, v233
    s_nop 0
    v_add_f32_dpp v226, v226, v226 quad_perm:[1,0,3,2] row_mask:0xf bank_mask:0xf
    v_add_f32_dpp v232, v232, v232 quad_perm:[1,0,3,2] row_mask:0xf bank_mask:0xf
    s_nop 0
    v_add_f32_dpp v226, v226, v226 quad_perm:[2,3,0,1] row_mask:0xf bank_mask:0xf
    v_add_f32_dpp v232, v232, v232 quad_perm:[2,3,0,1] row_mask:0xf bank_mask:0xf
    s_nop 0
    v_add_f32_dpp v226, v226, v226 row_half_mirror row_mask:0xf bank_mask:0xf
    v_add_f32_dpp v232, v232, v232 row_half_mirror row_mask:0xf bank_mask:0xf
    s_nop 0
    v_add_f32_dpp v226, v226, v226 row_mirror row_mask:0xf bank_mask:0xf
    v_add_f32_dpp v232, v232, v232 row_mirror row_mask:0xf bank_mask:0xf
    s_nop 0
    v_add_f32_dpp v226, v226, v226 row_bcast:15 row_mask:0xa bank_mask:0xf
    v_add_f32_dpp v232, v232, v232 row_bcast:15 row_mask:0xa bank_mask:0xf
    s_nop 0
    v_add_f32_dpp v226, v226, v226 row_bcast:31 row_mask:0xc bank_mask:0xf
    v_add_f32_dpp v232, v232, v232 row_bcast:31 row_mask:0xc bank_mask:0xf
    v_mul_f32 v226, s59, v226
    v_mul_f32 v232, s59, v232
    v_fma_f32 v232, -v226, v226, v232
    v_max_f32 v232, 0, v232
    v_cvt_pk_bf16_f32 v232, v232, v232
    v_add_f32 v226, v226, v224
    v_and_b32 v232, s51, v232
    v_cvt_pk_bf16_f32 v226, v226, v226
    v_add_f32 v232, 0x3727c5ac, v232
    v_and_b32 v226, s51, v226
    v_cvt_pk_bf16_f32 v232, v232, v232
    v_readlane_b32 s60, v226, 63
    v_and_b32 v232, s51, v232
    v_sqrt_f32 v232, v232
    v_pk_add_f32 v[182:183], v[172:173], s[60:61] op_sel_hi:[1,0] neg_lo:[0,1] neg_hi:[0,1]
    v_cvt_pk_bf16_f32 v232, v232, v232
    v_pk_add_f32 v[184:185], v[174:175], s[60:61] op_sel_hi:[1,0] neg_lo:[0,1] neg_hi:[0,1]
    v_pk_add_f32 v[186:187], v[176:177], s[60:61] op_sel_hi:[1,0] neg_lo:[0,1] neg_hi:[0,1]
    v_and_b32 v232, s51, v232
    v_pk_add_f32 v[188:189], v[178:179], s[60:61] op_sel_hi:[1,0] neg_lo:[0,1] neg_hi:[0,1]
    v_subrev_f32 v190, s60, v180
    v_rcp_f32 v232, v232
    v_cvt_pk_bf16_f32 v192, v182, v183
    v_cvt_pk_bf16_f32 v193, v184, v185
    v_readlane_b32 s62, v232, 63
    v_cvt_pk_bf16_f32 v194, v186, v187
    v_cvt_pk_bf16_f32 v195, v188, v189
    v_cvt_pk_bf16_f32 v196, v190, v190
    v_lshlrev_b32 v182, 16, v192
    v_and_b32 v183, s51, v192
    v_lshlrev_b32 v184, 16, v193
    v_and_b32 v185, s51, v193
    v_lshlrev_b32 v186, 16, v194
    v_and_b32 v187, s51, v194
    v_lshlrev_b32 v188, 16, v195
    v_and_b32 v189, s51, v195
    v_and_b32 v190, s51, v196
    v_pk_mul_f32 v[182:183], v[182:183], s[62:63] op_sel_hi:[1,0]
    v_pk_mul_f32 v[184:185], v[184:185], s[62:63] op_sel_hi:[1,0]
    v_pk_mul_f32 v[186:187], v[186:187], s[62:63] op_sel_hi:[1,0]
    v_pk_mul_f32 v[188:189], v[188:189], s[62:63] op_sel_hi:[1,0]
    v_mul_f32 v190, s62, v190
    v_cvt_pk_bf16_f32 v192, v182, v183
    v_cvt_pk_bf16_f32 v193, v184, v185
    v_cvt_pk_bf16_f32 v194, v186, v187
    v_cvt_pk_bf16_f32 v195, v188, v189
    v_cvt_pk_bf16_f32 v196, v190, v190
    v_lshlrev_b32 v182, 16, v192
    v_and_b32 v183, s51, v192
    v_lshlrev_b32 v184, 16, v193
    v_and_b32 v185, s51, v193
    v_lshlrev_b32 v186, 16, v194
    v_and_b32 v187, s51, v194
    v_lshlrev_b32 v188, 16, v195
    v_and_b32 v189, s51, v195
    v_and_b32 v190, s51, v196
    v_pk_add_f32 v[226:227], v[182:183], v[184:185]
    v_pk_mul_f32 v[232:233], v[182:183], v[182:183]
    v_pk_add_f32 v[234:235], v[186:187], v[188:189]
    v_pk_fma_f32 v[232:233], v[184:185], v[184:185], v[232:233]
    v_pk_add_f32 v[226:227], v[226:227], v[234:235]
    v_pk_fma_f32 v[232:233], v[186:187], v[186:187], v[232:233]
    v_add_f32 v226, v226, v190
    v_pk_fma_f32 v[232:233], v[188:189], v[188:189], v[232:233]
    v_fmac_f32 v232, v190, v190
    v_add_f32 v226, v226, v227
    v_add_f32 v232, v232, v233
    s_nop 0
    v_add_f32_dpp v226, v226, v226 quad_perm:[1,0,3,2] row_mask:0xf bank_mask:0xf
    v_add_f32_dpp v232, v232, v232 quad_perm:[1,0,3,2] row_mask:0xf bank_mask:0xf
    s_nop 0
    v_add_f32_dpp v226, v226, v226 quad_perm:[2,3,0,1] row_mask:0xf bank_mask:0xf
    v_add_f32_dpp v232, v232, v232 quad_perm:[2,3,0,1] row_mask:0xf bank_mask:0xf
    s_nop 0
    v_add_f32_dpp v226, v226, v226 row_half_mirror row_mask:0xf bank_mask:0xf
    v_add_f32_dpp v232, v232, v232 row_half_mirror row_mask:0xf bank_mask:0xf
    s_nop 0
    v_add_f32_dpp v226, v226, v226 row_mirror row_mask:0xf bank_mask:0xf
    v_add_f32_dpp v232, v232, v232 row_mirror row_mask:0xf bank_mask:0xf
    s_nop 0
    v_add_f32_dpp v226, v226, v226 row_bcast:15 row_mask:0xa bank_mask:0xf
    v_add_f32_dpp v232, v232, v232 row_bcast:15 row_mask:0xa bank_mask:0xf
    s_nop 0
    v_add_f32_dpp v226, v226, v226 row_bcast:31 row_mask:0xc bank_mask:0xf
    v_add_f32_dpp v232, v232, v232 row_bcast:31 row_mask:0xc bank_mask:0xf
    v_mul_f32 v226, s59, v226
    v_mul_f32 v232, s59, v232
    v_fma_f32 v232, -v226, v226, v232
    v_max_f32 v232, 0, v232
    v_cvt_pk_bf16_f32 v232, v232, v232
    v_and_b32 v232, s51, v232
    v_cvt_pk_bf16_f32 v226, v226, v226
    v_add_f32 v232, 0x3727c5ac, v232
    v_and_b32 v226, s51, v226
    v_cvt_pk_bf16_f32 v232, v232, v232
    v_readlane_b32 s60, v226, 63
    v_and_b32 v232, s51, v232
    v_sqrt_f32 v232, v232
    v_pk_add_f32 v[182:183], v[182:183], s[60:61] op_sel_hi:[1,0] neg_lo:[0,1] neg_hi:[0,1]
    v_cvt_pk_bf16_f32 v232, v232, v232
    v_pk_add_f32 v[184:185], v[184:185], s[60:61] op_sel_hi:[1,0] neg_lo:[0,1] neg_hi:[0,1]
    v_pk_add_f32 v[186:187], v[186:187], s[60:61] op_sel_hi:[1,0] neg_lo:[0,1] neg_hi:[0,1]
    v_and_b32 v232, s51, v232
    v_pk_add_f32 v[188:189], v[188:189], s[60:61] op_sel_hi:[1,0] neg_lo:[0,1] neg_hi:[0,1]
    v_subrev_f32 v190, s60, v190
    v_rcp_f32 v232, v232
    v_cvt_pk_bf16_f32 v192, v182, v183
    v_cvt_pk_bf16_f32 v193, v184, v185
    v_readlane_b32 s62, v232, 63
    v_cvt_pk_bf16_f32 v194, v186, v187
    v_cvt_pk_bf16_f32 v195, v188, v189
    v_cvt_pk_bf16_f32 v196, v190, v190
    v_lshlrev_b32 v182, 16, v192
    v_and_b32 v183, s51, v192
    v_lshlrev_b32 v184, 16, v193
    v_and_b32 v185, s51, v193
    v_lshlrev_b32 v186, 16, v194
    v_and_b32 v187, s51, v194
    v_lshlrev_b32 v188, 16, v195
    v_and_b32 v189, s51, v195
    v_and_b32 v190, s51, v196
    v_pk_mul_f32 v[182:183], v[182:183], s[62:63] op_sel_hi:[1,0]
    v_pk_mul_f32 v[184:185], v[184:185], s[62:63] op_sel_hi:[1,0]
    v_pk_mul_f32 v[186:187], v[186:187], s[62:63] op_sel_hi:[1,0]
    v_pk_mul_f32 v[188:189], v[188:189], s[62:63] op_sel_hi:[1,0]
    v_mul_f32 v190, s62, v190
    v_cvt_pk_bf16_f32 v192, v182, v183
    v_cvt_pk_bf16_f32 v193, v184, v185
    v_cvt_pk_bf16_f32 v194, v186, v187
    v_cvt_pk_bf16_f32 v195, v188, v189
    v_cvt_pk_bf16_f32 v196, v190, v190
    v_lshlrev_b32_sdwa v214, v26, v192 dst_sel:DWORD dst_unused:UNUSED_PAD src0_sel:DWORD src1_sel:WORD_0
    v_lshlrev_b32_sdwa v215, v26, v192 dst_sel:DWORD dst_unused:UNUSED_PAD src0_sel:DWORD src1_sel:WORD_1
    v_lshlrev_b32_sdwa v216, v26, v193 dst_sel:DWORD dst_unused:UNUSED_PAD src0_sel:DWORD src1_sel:WORD_0
    v_lshlrev_b32_sdwa v217, v26, v193 dst_sel:DWORD dst_unused:UNUSED_PAD src0_sel:DWORD src1_sel:WORD_1
    v_lshlrev_b32_sdwa v218, v26, v194 dst_sel:DWORD dst_unused:UNUSED_PAD src0_sel:DWORD src1_sel:WORD_0
    v_lshlrev_b32_sdwa v219, v26, v194 dst_sel:DWORD dst_unused:UNUSED_PAD src0_sel:DWORD src1_sel:WORD_1
    v_lshlrev_b32_sdwa v220, v26, v195 dst_sel:DWORD dst_unused:UNUSED_PAD src0_sel:DWORD src1_sel:WORD_0
    v_lshlrev_b32_sdwa v221, v26, v195 dst_sel:DWORD dst_unused:UNUSED_PAD src0_sel:DWORD src1_sel:WORD_1
    v_lshlrev_b32_sdwa v222, v26, v196 dst_sel:DWORD dst_unused:UNUSED_PAD src0_sel:DWORD src1_sel:WORD_0
    ds_read_u16_d16_hi v204, v214
    ds_read_u16_d16_hi v205, v215
    ds_read_u16_d16_hi v206, v216
    ds_read_u16_d16_hi v207, v217
    ds_read_u16_d16_hi v208, v218
    ds_read_u16_d16_hi v209, v219
    ds_read_u16_d16_hi v210, v220
    ds_read_u16_d16_hi v211, v221
    ds_read_u16_d16_hi v212, v222
    v_and_b32 v182, 0xffff, v214
    v_and_b32 v183, 0xffff, v215
    v_and_b32 v184, 0xffff, v216
    v_and_b32 v185, 0xffff, v217
    v_and_b32 v186, 0xffff, v218
    v_and_b32 v187, 0xffff, v219
    v_and_b32 v188, 0xffff, v220
    v_and_b32 v189, 0xffff, v221
    v_and_b32 v190, 0xffff, v222
    v_subrev_u32 v182, 27648, v182
    v_subrev_u32 v183, 27648, v183
    v_subrev_u32 v184, 27648, v184
    v_subrev_u32 v185, 27648, v185
    v_subrev_u32 v186, 27648, v186
    v_subrev_u32 v187, 27648, v187
    v_subrev_u32 v188, 27648, v188
    v_subrev_u32 v189, 27648, v189
    v_subrev_u32 v190, 27648, v190
    v_max3_u32 v234, v182, v183, v184
    v_max3_u32 v235, v185, v186, v187
    v_max3_u32 v234, v234, v188, v189
    v_max3_u32 v234, v234, v235, v190
    v_cmp_le_u32 vcc, 6144, v234
    s_waitcnt lgkmcnt(0)
    s_cbranch_vccnz L_fb
L_out:
    v_pk_add_f32 v[204:205], v[204:205], v[172:173]
    v_pk_add_f32 v[206:207], v[206:207], v[174:175]
    v_pk_add_f32 v[208:209], v[208:209], v[176:177]
    v_pk_add_f32 v[210:211], v[210:211], v[178:179]
    v_add_f32 v212, v212, v180
    s_cbranch_execz L_dryret
    v_cvt_pk_bf16_f32 v192, v204, v205
    global_store_dword v168, v192, s[24:25] offset:0
    v_cvt_pk_bf16_f32 v193, v206, v207
    global_store_dword v168, v193, s[24:25] offset:256
    v_cvt_pk_bf16_f32 v194, v208, v209
    global_store_dword v168, v194, s[24:25] offset:512
    v_cvt_pk_bf16_f32 v195, v210, v211
    global_store_dword v168, v195, s[24:25] offset:768
    v_cvt_pk_bf16_f32 v196, v212, v212
    global_store_short v169, v196, s[24:25] offset:1024
L_fin:
    s_cbranch_execz L_dryret
L_end:
    s_endpgm
L_w0:
    s_setprio 3
    v_mov_b32 v27, 0
    ds_write2_b32 v27, v27, v27 offset0:193 offset1:194
    v_mul_u32_u24 v164, 36, v1
    s_and_b32 s56, s2, 7
    v_lshrrev_b32 v166, 4, v1
    s_mov_b32 s40, s10
    s_mov_b32 s41, s11
    s_mov_b32 s42, 4718592
    s_mov_b32 s43, 0x20000
    s_mul_i32 s57, s56, 589824
    s_bfe_u32 s55, s2, 0x40003
    s_lshr_b32 s61, s2, 7
    s_lshl1_add_u32 s60, s55, s61
    s_lshl3_add_u32 s76, s60, s56
    s_lshl_b32 s60, s60, 8
    s_add_u32 s57, s57, s60
    v_mul_u32_u24 v167, 147456, v166
    v_and_b32 v168, 15, v1
    v_lshl_add_u32 v167, v168, 4, v167
    s_mul_i32 s59, s56, 144
    v_bfe_u32 v165, v1, 3, 1
    v_mul_u32_u24 v165, 1152, v165
    v_mad_u32_u24 v165, v166, 36, v165
    v_add_u32 v165, s59, v165
    s_waitcnt lgkmcnt(0)
    s_barrier
    global_load_dwordx3 v[172:174], v164, s[4:5] offset:0
    global_load_dwordx3 v[176:178], v164, s[4:5] offset:12
    global_load_dwordx3 v[180:182], v164, s[4:5] offset:24
    global_load_dwordx3 v[184:186], v165, s[4:5] offset:0
    global_load_dwordx3 v[188:190], v165, s[4:5] offset:12
    global_load_dwordx3 v[192:194], v165, s[4:5] offset:24
    global_load_dword v232, v27, s[28:29] offset:0
    buffer_load_dwordx4 v[36:39], v167, s[40:43], s57 offen nt
    s_add_u32 s57, s57, 0x2000
    buffer_load_dwordx4 v[40:43], v167, s[40:43], s57 offen nt
    s_add_u32 s57, s57, 0x2000
    buffer_load_dwordx4 v[44:47], v167, s[40:43], s57 offen nt
    s_add_u32 s57, s57, 0x2000
    buffer_load_dwordx4 v[48:51], v167, s[40:43], s57 offen nt
    s_add_u32 s57, s57, 0x2000
    buffer_load_dwordx4 v[52:55], v167, s[40:43], s57 offen nt
    s_add_u32 s57, s57, 0x2000
    buffer_load_dwordx4 v[56:59], v167, s[40:43], s57 offen nt
    s_add_u32 s57, s57, 0x2000
    buffer_load_dwordx4 v[60:63], v167, s[40:43], s57 offen nt
    s_add_u32 s57, s57, 0x2000
    buffer_load_dwordx4 v[64:67], v167, s[40:43], s57 offen nt
    s_add_u32 s57, s57, 0x2000
    buffer_load_dwordx4 v[68:71], v167, s[40:43], s57 offen nt
    s_add_u32 s57, s57, 0x2000
    buffer_load_dwordx4 v[72:75], v167, s[40:43], s57 offen nt
    s_add_u32 s57, s57, 0x2000
    buffer_load_dwordx4 v[76:79], v167, s[40:43], s57 offen nt
    s_add_u32 s57, s57, 0x2000
    buffer_load_dwordx4 v[80:83], v167, s[40:43], s57 offen nt
    s_add_u32 s57, s57, 0x2000
    buffer_load_dwordx4 v[84:87], v167, s[40:43], s57 offen nt
    s_add_u32 s57, s57, 0x2000
    buffer_load_dwordx4 v[88:91], v167, s[40:43], s57 offen nt
    s_add_u32 s57, s57, 0x2000
    buffer_load_dwordx4 v[92:95], v167, s[40:43], s57 offen nt
    s_add_u32 s57, s57, 0x2000
    buffer_load_dwordx4 v[96:99], v167, s[40:43], s57 offen nt
    s_add_u32 s57, s57, 0x2000
    buffer_load_dwordx4 v[100:103], v167, s[40:43], s57 offen nt
    s_add_u32 s57, s57, 0x2000
    buffer_load_dwordx4 v[104:107], v167, s[40:43], s57 offen nt
    s_mov_b32 s51, 0xffff0000
    s_mov_b32 s52, 0x3db504f3
    s_mov_b32 s53, 0x3db504f3
    s_mov_b32 s54, 0x3fb8aa3b
    s_mov_b32 s77, 16777216
    s_bfe_u32 s55, s2, 0x40003
    v_and_b32 v169, 1, v1
    v_lshlrev_b32 v169, 4, v169
    v_mov_b32 v170, 0xffff
    v_lshlrev_b32 v169, v169, v170
    v_bfe_u32 v170, v1, 1, 2
    v_cmp_eq_u32 vcc, 0, v170
    v_mov_b32 v16, 0
    s_nop 0
    v_cndmask_b32 v12, 0, v169, vcc
    v_cmp_eq_u32 vcc, 1, v170
    v_mov_b32 v17, 0
    s_nop 0
    v_cndmask_b32 v13, 0, v169, vcc
    v_cmp_eq_u32 vcc, 2, v170
    v_mov_b32 v18, 0
    s_nop 0
    v_cndmask_b32 v14, 0, v169, vcc
    v_cmp_eq_u32 vcc, 3, v170
    v_mov_b32 v19, 0
    s_nop 0
    v_cndmask_b32 v15, 0, v169, vcc
    v_mov_b32 v20, 0xff7fffff
    v_mov_b32 v21, 0
    s_and_b32 s56, s2, 7
    s_lshr_b32 s57, s2, 7
    s_lshl1_add_u32 s78, s56, s57
    v_bfe_u32 v28, v1, 3, 1
    v_lshlrev_b32 v28, 6, v28
    s_lshl_b32 s56, s3, 3
    v_add_u32 v28, s56, v28
    v_mov_b32 v26, 1
    v_mov_b32 v25, 4
    v_mov_b32 v27, 0
    v_mov_b32 v30, 0
    v_mov_b32 v228, -1
    v_lshlrev_b32 v238, 2, v1
    v_mov_b32 v236, 0xfffff9a8
    ds_write2_b32 v27, v236, v27 offset0:195 offset1:196
    ds_write2_b32 v27, v20, v20 offset0:198 offset1:199
    ds_write2_b32 v27, v27, v27 offset0:200 offset1:201
    ds_write_b32 v27, v27 offset:788
    ds_write2st64_b32 v238, v228, v228 offset0:64 offset1:68
    ds_write2st64_b32 v238, v228, v228 offset0:65 offset1:69
    ds_write2st64_b32 v238, v228, v228 offset0:66 offset1:70
    ds_write2st64_b32 v238, v228, v228 offset0:67 offset1:71
    s_waitcnt vmcnt(22)
    v_lshlrev_b32 v196, 16, v172
    v_and_b32 v197, s51, v172
    v_lshlrev_b32 v198, 16, v173
    v_and_b32 v199, s51, v173
    v_lshlrev_b32 v200, 16, v174
    v_and_b32 v201, s51, v174
    v_lshlrev_b32 v202, 16, v176
    v_and_b32 v203, s51, v176
    v_lshlrev_b32 v204, 16, v177
    v_and_b32 v205, s51, v177
    v_lshlrev_b32 v206, 16, v178
    v_and_b32 v207, s51, v178
    v_lshlrev_b32 v208, 16, v180
    v_and_b32 v209, s51, v180
    v_lshlrev_b32 v210, 16, v181
    v_and_b32 v211, s51, v181
    v_lshlrev_b32 v212, 16, v182
    v_and_b32 v213, s51, v182
    v_add_f32 v164, v196, v197
    v_add_f32 v165, v198, v199
    v_add_f32 v164, v164, v200
    v_add_f32 v165, v165, v201
    v_add_f32 v164, v164, v202
    v_add_f32 v165, v165, v203
    v_add_f32 v164, v164, v204
    v_add_f32 v165, v165, v205
    v_add_f32 v164, v164, v206
    v_add_f32 v165, v165, v207
    v_add_f32 v164, v164, v208
    v_add_f32 v165, v165, v209
    v_add_f32 v164, v164, v210
    v_add_f32 v165, v165, v211
    v_add_f32 v164, v164, v212
    v_add_f32 v165, v165, v213
    v_add_f32 v164, v164, v165
    s_nop 1
    v_add_f32_dpp v164, v164, v164 quad_perm:[1,0,3,2] row_mask:0xf bank_mask:0xf
    s_nop 1
    v_add_f32_dpp v164, v164, v164 quad_perm:[2,3,0,1] row_mask:0xf bank_mask:0xf
    s_nop 1
    v_add_f32_dpp v164, v164, v164 row_half_mirror row_mask:0xf bank_mask:0xf
    s_nop 1
    v_add_f32_dpp v164, v164, v164 row_mirror row_mask:0xf bank_mask:0xf
    v_mov_b32 v166, v164
    s_nop 1
    v_permlane16_swap_b32 v164, v166
    s_nop 0
    v_add_f32 v164, v164, v166
    v_mul_f32 v164, 0x3ae38e39, v164
    v_sub_f32 v196, v196, v164
    v_sub_f32 v197, v197, v164
    v_sub_f32 v198, v198, v164
    v_sub_f32 v199, v199, v164
    v_sub_f32 v200, v200, v164
    v_sub_f32 v201, v201, v164
    v_sub_f32 v202, v202, v164
    v_sub_f32 v203, v203, v164
    v_sub_f32 v204, v204, v164
    v_sub_f32 v205, v205, v164
    v_sub_f32 v206, v206, v164
    v_sub_f32 v207, v207, v164
    v_sub_f32 v208, v208, v164
    v_sub_f32 v209, v209, v164
    v_sub_f32 v210, v210, v164
    v_sub_f32 v211, v211, v164
    v_sub_f32 v212, v212, v164
    v_sub_f32 v213, v213, v164
    v_mul_f32 v165, v196, v196
    v_mul_f32 v166, v197, v197
    v_fmac_f32 v165, v198, v198
    v_fmac_f32 v166, v199, v199
    v_fmac_f32 v165, v200, v200
    v_fmac_f32 v166, v201, v201
    v_fmac_f32 v165, v202, v202
    v_fmac_f32 v166, v203, v203
    v_fmac_f32 v165, v204, v204
    v_fmac_f32 v166, v205, v205
    v_fmac_f32 v165, v206, v206
    v_fmac_f32 v166, v207, v207
    v_fmac_f32 v165, v208, v208
    v_fmac_f32 v166, v209, v209
    v_fmac_f32 v165, v210, v210
    v_fmac_f32 v166, v211, v211
    v_fmac_f32 v165, v212, v212
    v_fmac_f32 v166, v213, v213
    v_add_f32 v165, v165, v166
    s_nop 1
    v_add_f32_dpp v165, v165, v165 quad_perm:[1,0,3,2] row_mask:0xf bank_mask:0xf
    s_nop 1
    v_add_f32_dpp v165, v165, v165 quad_perm:[2,3,0,1] row_mask:0xf bank_mask:0xf
    s_nop 1
    v_add_f32_dpp v165, v165, v165 row_half_mirror row_mask:0xf bank_mask:0xf
    s_nop 1
    v_add_f32_dpp v165, v165, v165 row_mirror row_mask:0xf bank_mask:0xf
    v_mov_b32 v166, v165
    s_nop 1
    v_permlane16_swap_b32 v165, v166
    s_nop 0
    v_add_f32 v165, v165, v166
    v_mul_f32 v165, 0x3ae38e39, v165
    v_cvt_pk_bf16_f32 v164, v164, v164
    v_and_b32 v164, s51, v164
    v_cvt_pk_bf16_f32 v165, v165, v165
    v_and_b32 v165, s51, v165
    v_add_f32 v165, 0x3727c5ac, v165
    v_cvt_pk_bf16_f32 v165, v165, v165
    v_and_b32 v165, s51, v165
    v_sqrt_f32 v165, v165
    s_nop 0
    v_cvt_pk_bf16_f32 v165, v165, v165
    v_and_b32 v165, s51, v165
    v_rcp_f32 v165, v165
    s_nop 1
    v_readlane_b32 s56, v164, 0
    v_readlane_b32 s57, v164, 32
    v_readlane_b32 s58, v165, 0
    v_readlane_b32 s59, v165, 32
    v_and_b32 v166, 8, v1
    v_cmp_eq_u32 vcc, 0, v166
    v_mov_b32 v164, s56
    v_mov_b32 v165, s58
    v_mov_b32 v167, s57
    v_mov_b32 v168, s59
    v_cndmask_b32 v164, v167, v164, vcc
    v_cndmask_b32 v165, v168, v165, vcc
    s_waitcnt vmcnt(19)
    v_lshlrev_b32 v196, 16, v184
    v_and_b32 v197, s51, v184
    v_lshlrev_b32 v198, 16, v185
    v_and_b32 v199, s51, v185
    v_lshlrev_b32 v200, 16, v186
    v_and_b32 v201, s51, v186
    v_lshlrev_b32 v202, 16, v188
    v_and_b32 v203, s51, v188
    v_lshlrev_b32 v204, 16, v189
    v_and_b32 v205, s51, v189
    v_lshlrev_b32 v206, 16, v190
    v_and_b32 v207, s51, v190
    v_lshlrev_b32 v208, 16, v192
    v_and_b32 v209, s51, v192
    v_lshlrev_b32 v210, 16, v193
    v_and_b32 v211, s51, v193
    v_lshlrev_b32 v212, 16, v194
    v_and_b32 v213, s51, v194
    v_sub_f32 v196, v196, v164
    v_sub_f32 v197, v197, v164
    v_sub_f32 v198, v198, v164
    v_sub_f32 v199, v199, v164
    v_sub_f32 v200, v200, v164
    v_sub_f32 v201, v201, v164
    v_sub_f32 v202, v202, v164
    v_sub_f32 v203, v203, v164
    v_sub_f32 v204, v204, v164
    v_sub_f32 v205, v205, v164
    v_sub_f32 v206, v206, v164
    v_sub_f32 v207, v207, v164
    v_sub_f32 v208, v208, v164
    v_sub_f32 v209, v209, v164
    v_sub_f32 v210, v210, v164
    v_sub_f32 v211, v211, v164
    v_sub_f32 v212, v212, v164
    v_sub_f32 v213, v213, v164
    v_cvt_pk_bf16_f32 v172, v196, v197
    v_cvt_pk_bf16_f32 v173, v198, v199
    v_cvt_pk_bf16_f32 v174, v200, v201
    v_cvt_pk_bf16_f32 v175, v202, v203
    v_cvt_pk_bf16_f32 v176, v204, v205
    v_cvt_pk_bf16_f32 v177, v206, v207
    v_cvt_pk_bf16_f32 v178, v208, v209
    v_cvt_pk_bf16_f32 v179, v210, v211
    v_cvt_pk_bf16_f32 v180, v212, v213
    v_lshlrev_b32 v196, 16, v172
    v_and_b32 v197, s51, v172
    v_lshlrev_b32 v198, 16, v173
    v_and_b32 v199, s51, v173
    v_lshlrev_b32 v200, 16, v174
    v_and_b32 v201, s51, v174
    v_lshlrev_b32 v202, 16, v175
    v_and_b32 v203, s51, v175
    v_lshlrev_b32 v204, 16, v176
    v_and_b32 v205, s51, v176
    v_lshlrev_b32 v206, 16, v177
    v_and_b32 v207, s51, v177
    v_lshlrev_b32 v208, 16, v178
    v_and_b32 v209, s51, v178
    v_lshlrev_b32 v210, 16, v179
    v_and_b32 v211, s51, v179
    v_lshlrev_b32 v212, 16, v180
    v_and_b32 v213, s51, v180
    v_mul_f32 v196, v196, v165
    v_mul_f32 v197, v197, v165
    v_mul_f32 v198, v198, v165
    v_mul_f32 v199, v199, v165
    v_mul_f32 v200, v200, v165
    v_mul_f32 v201, v201, v165
    v_mul_f32 v202, v202, v165
    v_mul_f32 v203, v203, v165
    v_mul_f32 v204, v204, v165
    v_mul_f32 v205, v205, v165
    v_mul_f32 v206, v206, v165
    v_mul_f32 v207, v207, v165
    v_mul_f32 v208, v208, v165
    v_mul_f32 v209, v209, v165
    v_mul_f32 v210, v210, v165
    v_mul_f32 v211, v211, v165
    v_mul_f32 v212, v212, v165
    v_mul_f32 v213, v213, v165
    v_cvt_pk_bf16_f32 v196, v196, v196
    v_cvt_pk_bf16_f32 v197, v197, v197
    v_cvt_pk_bf16_f32 v198, v198, v198
    v_cvt_pk_bf16_f32 v199, v199, v199
    v_cvt_pk_bf16_f32 v200, v200, v200
    v_cvt_pk_bf16_f32 v201, v201, v201
    v_cvt_pk_bf16_f32 v202, v202, v202
    v_cvt_pk_bf16_f32 v203, v203, v203
    v_cvt_pk_bf16_f32 v204, v204, v204
    v_cvt_pk_bf16_f32 v205, v205, v205
    v_cvt_pk_bf16_f32 v206, v206, v206
    v_cvt_pk_bf16_f32 v207, v207, v207
    v_cvt_pk_bf16_f32 v208, v208, v208
    v_cvt_pk_bf16_f32 v209, v209, v209
    v_cvt_pk_bf16_f32 v210, v210, v210
    v_cvt_pk_bf16_f32 v211, v211, v211
    v_cvt_pk_bf16_f32 v212, v212, v212
    v_cvt_pk_bf16_f32 v213, v213, v213
    v_and_b32 v216, v12, v196
    v_and_b32 v217, v13, v196
    v_and_b32 v218, v14, v196
    v_and_b32 v219, v15, v196
    v_and_b32 v220, v12, v197
    v_and_b32 v221, v13, v197
    v_and_b32 v222, v14, v197
    v_and_b32 v223, v15, v197
    s_waitcnt vmcnt(17)
    v_mfma_f32_16x16x32_bf16 v[224:227], v[36:39], v[216:219], 0
    v_and_b32 v216, v12, v198
    v_and_b32 v217, v13, v198
    v_and_b32 v218, v14, v198
    v_and_b32 v219, v15, v198
    s_waitcnt vmcnt(16)
    v_mfma_f32_16x16x32_bf16 v[224:227], v[40:43], v[220:223], v[224:227]
    v_and_b32 v220, v12, v199
    v_and_b32 v221, v13, v199
    v_and_b32 v222, v14, v199
    v_and_b32 v223, v15, v199
    s_waitcnt vmcnt(15)
    v_mfma_f32_16x16x32_bf16 v[224:227], v[44:47], v[216:219], v[224:227]
    v_and_b32 v216, v12, v200
    v_and_b32 v217, v13, v200
    v_and_b32 v218, v14, v200
    v_and_b32 v219, v15, v200
    s_waitcnt vmcnt(14)
    v_mfma_f32_16x16x32_bf16 v[224:227], v[48:51], v[220:223], v[224:227]
    v_and_b32 v220, v12, v201
    v_and_b32 v221, v13, v201
    v_and_b32 v222, v14, v201
    v_and_b32 v223, v15, v201
    s_waitcnt vmcnt(13)
    v_mfma_f32_16x16x32_bf16 v[224:227], v[52:55], v[216:219], v[224:227]
    v_and_b32 v216, v12, v202
    v_and_b32 v217, v13, v202
    v_and_b32 v218, v14, v202
    v_and_b32 v219, v15, v202
    s_waitcnt vmcnt(12)
    v_mfma_f32_16x16x32_bf16 v[224:227], v[56:59], v[220:223], v[224:227]
    v_and_b32 v220, v12, v203
    v_and_b32 v221, v13, v203
    v_and_b32 v222, v14, v203
    v_and_b32 v223, v15, v203
    s_waitcnt vmcnt(11)
    v_mfma_f32_16x16x32_bf16 v[224:227], v[60:63], v[216:219], v[224:227]
    v_and_b32 v216, v12, v204
    v_and_b32 v217, v13, v204
    v_and_b32 v218, v14, v204
    v_and_b32 v219, v15, v204
    s_waitcnt vmcnt(10)
    v_mfma_f32_16x16x32_bf16 v[224:227], v[64:67], v[220:223], v[224:227]
    v_and_b32 v220, v12, v205
    v_and_b32 v221, v13, v205
    v_and_b32 v222, v14, v205
    v_and_b32 v223, v15, v205
    s_waitcnt vmcnt(9)
    v_mfma_f32_16x16x32_bf16 v[224:227], v[68:71], v[216:219], v[224:227]
    v_and_b32 v216, v12, v206
    v_and_b32 v217, v13, v206
    v_and_b32 v218, v14, v206
    v_and_b32 v219, v15, v206
    s_waitcnt vmcnt(8)
    v_mfma_f32_16x16x32_bf16 v[224:227], v[72:75], v[220:223], v[224:227]
    v_and_b32 v220, v12, v207
    v_and_b32 v221, v13, v207
    v_and_b32 v222, v14, v207
    v_and_b32 v223, v15, v207
    s_waitcnt vmcnt(7)
    v_mfma_f32_16x16x32_bf16 v[224:227], v[76:79], v[216:219], v[224:227]
    v_and_b32 v216, v12, v208
    v_and_b32 v217, v13, v208
    v_and_b32 v218, v14, v208
    v_and_b32 v219, v15, v208
    s_waitcnt vmcnt(6)
    v_mfma_f32_16x16x32_bf16 v[224:227], v[80:83], v[220:223], v[224:227]
    v_and_b32 v220, v12, v209
    v_and_b32 v221, v13, v209
    v_and_b32 v222, v14, v209
    v_and_b32 v223, v15, v209
    s_waitcnt vmcnt(5)
    v_mfma_f32_16x16x32_bf16 v[224:227], v[84:87], v[216:219], v[224:227]
    v_and_b32 v216, v12, v210
    v_and_b32 v217, v13, v210
    v_and_b32 v218, v14, v210
    v_and_b32 v219, v15, v210
    s_waitcnt vmcnt(4)
    v_mfma_f32_16x16x32_bf16 v[224:227], v[88:91], v[220:223], v[224:227]
    v_and_b32 v220, v12, v211
    v_and_b32 v221, v13, v211
    v_and_b32 v222, v14, v211
    v_and_b32 v223, v15, v211
    s_waitcnt vmcnt(3)
    v_mfma_f32_16x16x32_bf16 v[224:227], v[92:95], v[216:219], v[224:227]
    v_and_b32 v216, v12, v212
    v_and_b32 v217, v13, v212
    v_and_b32 v218, v14, v212
    v_and_b32 v219, v15, v212
    s_waitcnt vmcnt(2)
    v_mfma_f32_16x16x32_bf16 v[224:227], v[96:99], v[220:223], v[224:227]
    v_and_b32 v220, v12, v213
    v_and_b32 v221, v13, v213
    v_and_b32 v222, v14, v213
    v_and_b32 v223, v15, v213
    s_waitcnt vmcnt(1)
    v_mfma_f32_16x16x32_bf16 v[224:227], v[100:103], v[216:219], v[224:227]
    s_nop 1
    s_waitcnt vmcnt(0)
    v_mfma_f32_16x16x32_bf16 v[224:227], v[104:107], v[220:223], v[224:227]
    s_lshl_b32 s56, s76, 10
    s_add_u32 s56, s56, 65536
    v_add_u32 v164, s56, v3
    v_readfirstlane_b32 s50, v232
    v_and_b32 v182, 7, v1
    s_mul_i32 s50, s50, 1664525
    s_add_u32 s50, s50, 1013904223
    v_lshlrev_b32 v181, 2, v182
    v_alignbit_b32 v181, s50, s50, v181
    v_xor_b32 v183, s50, v182
    v_bfi_b32 v183, 1, v183, v181
    v_bfi_b32 v172, 63, v183, v224
    v_bfi_b32 v173, 63, v183, v225
    v_bfi_b32 v174, 63, v183, v226
    v_bfi_b32 v175, 63, v183, v227
    global_store_dwordx4 v164, v[172:175], s[28:29] sc1
    s_and_b32 s56, s76, 0xf8
    s_lshl_b32 s56, s56, 10
    s_and_b32 s57, s76, 7
    s_lshl_b32 s58, s57, 7
    s_add_u32 s56, s56, s58
    s_add_u32 s56, s56, 65536
    v_lshrrev_b32 v180, 3, v1
    v_lshl_add_u32 v180, v180, 10, s56
    v_lshl_add_u32 v180, v182, 4, v180
    s_lshl_b32 s56, s2, 8
    s_add_u32 s56, s56, 1048576
    v_add_u32 v182, s56, v3
    s_waitcnt vmcnt(0)
L_q1:
    global_load_dwordx4 v[36:39], v180, s[28:29] sc1
    s_waitcnt vmcnt(0)
    v_xor_b32 v166, v36, v183
    v_xor_b32 v167, v37, v183
    v_bitop3_b32 v166, v166, v38, v183 bitop3:0xf6
    v_bitop3_b32 v167, v167, v39, v183 bitop3:0xf6
    v_bitop3_b32 v166, v166, v167, 63 bitop3:0xa8
    v_cmp_ne_u32 vcc, 0, v166
    s_sub_u32 s77, s77, 16
    s_cbranch_scc1 L_end
    s_cbranch_vccnz L_q1
    v_add_f32_dpp v36, v36, v36 row_ror:8 row_mask:0xf bank_mask:0xf
    v_add_f32_dpp v37, v37, v37 row_ror:8 row_mask:0xf bank_mask:0xf
    v_add_f32_dpp v38, v38, v38 row_ror:8 row_mask:0xf bank_mask:0xf
    v_add_f32_dpp v39, v39, v39 row_ror:8 row_mask:0xf bank_mask:0xf
    v_mov_b32 v40, v36
    v_mov_b32 v41, v37
    v_mov_b32 v42, v38
    v_mov_b32 v43, v39
    s_nop 1
    v_permlane16_swap_b32 v36, v40
    v_permlane16_swap_b32 v37, v41
    v_permlane16_swap_b32 v38, v42
    v_permlane16_swap_b32 v39, v43
    s_nop 0
    v_add_f32 v36, v36, v40
    v_add_f32 v37, v37, v41
    v_add_f32 v38, v38, v42
    v_add_f32 v39, v39, v43
    v_mov_b32 v40, v36
    v_mov_b32 v41, v37
    v_mov_b32 v42, v38
    v_mov_b32 v43, v39
    s_nop 1
    v_permlane32_swap_b32 v36, v40
    v_permlane32_swap_b32 v37, v41
    v_permlane32_swap_b32 v38, v42
    v_permlane32_swap_b32 v39, v43
    s_nop 0
    v_add_f32 v36, v36, v40
    v_add_f32 v37, v37, v41
    v_add_f32 v38, v38, v42
    v_add_f32 v39, v39, v43
    v_cvt_pk_bf16_f32 v40, v36, v37
    v_cvt_pk_bf16_f32 v42, v38, v39
    v_mov_b32 v41, s50
    v_mov_b32 v43, s50
    v_writelane_b32 v40, 0, 8
    v_writelane_b32 v42, 0, 8
    s_mov_b64 exec, 0x1ff
    global_store_dwordx4 v182, v[40:43], s[28:29] sc1
    s_mov_b64 exec, -1
    s_lshr_b32 s56, s2, 7
    s_lshl3_add_u32 s56, s55, s56
    s_lshl_b32 s56, s56, 8
    s_add_u32 s56, s56, 1048576
    v_lshrrev_b32 v180, 5, v1
    v_lshl_add_u32 v180, v180, 15, s56
    v_bfe_u32 v168, v1, 3, 2
    v_lshl_add_u32 v180, v168, 9, v180
    v_and_b32 v168, 7, v1
    v_lshl_add_u32 v180, v168, 4, v180
    v_lshrrev_b32 v168, 3, v1
    v_lshlrev_b32 v168, 6, v168
    v_and_b32 v169, 7, v1
    v_lshl_add_u32 v168, v169, 1, v168
    v_mov_b32 v170, s50
    v_mov_b32 v171, 1
    s_waitcnt vmcnt(0)
L_q2:
    global_load_dwordx4 v[44:47], v180, s[28:29] sc1
    s_waitcnt vmcnt(0)
    v_max3_u32 v166, v45, v47, s50
    v_min3_u32 v167, v45, v47, s50
    v_cmp_ne_u32 vcc, v166, v167
    s_sub_u32 s77, s77, 16
    s_cbranch_scc1 L_end
    s_cbranch_vccnz L_q2
    ds_write_b16 v168, v44 offset:0
    ds_write_b16_d16_hi v168, v44 offset:16
    ds_write_b16 v168, v46 offset:32
    ds_write_b16_d16_hi v168, v46 offset:48
L_qe:
    ds_write_b64 v27, v[170:171] offset:768
    v_lshrrev_b32 v165, 2, v1
    v_lshlrev_b32 v164, 2, v165
    v_alignbit_b32 v164, s50, s50, v164
    v_xor_b32 v31, s50, v165
    v_bfi_b32 v31, 1, v31, v164
    s_waitcnt lgkmcnt(0)
L_help:
    s_setprio 3
    global_load_ushort v24, v27, s[22:23]
    s_mul_i32 s56, s3, 2304
    v_add_u32 v236, s56, v3
    v_lshl_add_u32 v237, v1, 2, s56
    global_load_dwordx4 v[128:131], v236, s[16:17] offset:0
    global_load_dwordx4 v[132:135], v236, s[16:17] offset:1024
    global_load_dword v136, v237, s[16:17] offset:2048
    global_load_dwordx4 v[140:143], v236, s[18:19] offset:0
    global_load_dwordx4 v[144:147], v236, s[18:19] offset:1024
    global_load_dword v148, v237, s[18:19] offset:2048
    global_load_dwordx4 v[152:155], v236, s[20:21] offset:0
    global_load_dwordx4 v[156:159], v236, s[20:21] offset:1024
    global_load_dword v160, v237, s[20:21] offset:2048
    s_waitcnt vmcnt(0)
    v_lshlrev_b32 v36, 16, v128
    v_and_b32 v37, s51, v128
    v_lshlrev_b32 v38, 16, v129
    v_and_b32 v39, s51, v129
    v_lshlrev_b32 v40, 16, v130
    v_and_b32 v41, s51, v130
    v_lshlrev_b32 v42, 16, v131
    v_and_b32 v43, s51, v131
    v_lshlrev_b32 v44, 16, v132
    v_and_b32 v45, s51, v132
    v_lshlrev_b32 v46, 16, v133
    v_and_b32 v47, s51, v133
    v_lshlrev_b32 v48, 16, v134
    v_and_b32 v49, s51, v134
    v_lshlrev_b32 v50, 16, v135
    v_and_b32 v51, s51, v135
    v_lshlrev_b32 v52, 16, v136
    v_and_b32 v53, s51, v136
    v_lshlrev_b32 v54, 16, v140
    v_and_b32 v55, s51, v140
    v_lshlrev_b32 v56, 16, v141
    v_and_b32 v57, s51, v141
    v_lshlrev_b32 v58, 16, v142
    v_and_b32 v59, s51, v142
    v_lshlrev_b32 v60, 16, v143
    v_and_b32 v61, s51, v143
    v_lshlrev_b32 v62, 16, v144
    v_and_b32 v63, s51, v144
    v_lshlrev_b32 v64, 16, v145
    v_and_b32 v65, s51, v145
    v_lshlrev_b32 v66, 16, v146
    v_and_b32 v67, s51, v146
    v_lshlrev_b32 v68, 16, v147
    v_and_b32 v69, s51, v147
    v_lshlrev_b32 v70, 16, v148
    v_and_b32 v71, s51, v148
    v_lshlrev_b32 v72, 16, v152
    v_and_b32 v73, s51, v152
    v_lshlrev_b32 v74, 16, v153
    v_and_b32 v75, s51, v153
    v_lshlrev_b32 v76, 16, v154
    v_and_b32 v77, s51, v154
    v_lshlrev_b32 v78, 16, v155
    v_and_b32 v79, s51, v155
    v_lshlrev_b32 v80, 16, v156
    v_and_b32 v81, s51, v156
    v_lshlrev_b32 v82, 16, v157
    v_and_b32 v83, s51, v157
    v_lshlrev_b32 v84, 16, v158
    v_and_b32 v85, s51, v158
    v_lshlrev_b32 v86, 16, v159
    v_and_b32 v87, s51, v159
    v_lshlrev_b32 v88, 16, v160
    v_and_b32 v89, s51, v160
    v_mov_b32 v136, 0xc0135761
    s_mov_b32 s58, 0xbdd2d3e8
    v_lshlrev_b32 v24, 16, v24
    s_and_b32 s56, s2, 127
    s_mul_i32 s56, s56, 24
    s_add_u32 s56, s56, 13824
    s_lshr_b32 s57, s2, 7
    s_lshl_b32 s57, s57, 15
    s_or_b32 s56, s56, s57
    s_lshl_b32 s79, s56, 16
    s_lshl_b32 s56, s3, 2
    v_mov_b32 v166, s56
    s_mov_b32 s49, 24
    s_setprio 0
L_tab:
    v_mul_f32 v90, s79, v36
    v_mul_f32 v91, s79, v37
    v_mul_f32 v92, s79, v38
    v_mul_f32 v93, s79, v39
    v_mul_f32 v94, s79, v40
    v_mul_f32 v95, s79, v41
    v_mul_f32 v96, s79, v42
    v_mul_f32 v97, s79, v43
    v_mul_f32 v98, s79, v44
    v_mul_f32 v99, s79, v45
    v_mul_f32 v100, s79, v46
    v_mul_f32 v101, s79, v47
    v_mul_f32 v102, s79, v48
    v_mul_f32 v103, s79, v49
    v_mul_f32 v104, s79, v50
    v_mul_f32 v105, s79, v51
    v_mul_f32 v106, s79, v52
    v_mul_f32 v107, s79, v53
    v_cvt_pk_bf16_f32 v126, v90, v91
    v_cvt_pk_bf16_f32 v127, v92, v93
    v_cvt_pk_bf16_f32 v128, v94, v95
    v_cvt_pk_bf16_f32 v129, v96, v97
    v_cvt_pk_bf16_f32 v130, v98, v99
    v_cvt_pk_bf16_f32 v131, v100, v101
    v_cvt_pk_bf16_f32 v132, v102, v103
    v_cvt_pk_bf16_f32 v133, v104, v105
    v_cvt_pk_bf16_f32 v134, v106, v107
    v_lshlrev_b32 v90, 16, v126
    v_and_b32 v91, s51, v126
    v_lshlrev_b32 v92, 16, v127
    v_and_b32 v93, s51, v127
    v_lshlrev_b32 v94, 16, v128
    v_and_b32 v95, s51, v128
    v_lshlrev_b32 v96, 16, v129
    v_and_b32 v97, s51, v129
    v_lshlrev_b32 v98, 16, v130
    v_and_b32 v99, s51, v130
    v_lshlrev_b32 v100, 16, v131
    v_and_b32 v101, s51, v131
    v_lshlrev_b32 v102, 16, v132
    v_and_b32 v103, s51, v132
    v_lshlrev_b32 v104, 16, v133
    v_and_b32 v105, s51, v133
    v_lshlrev_b32 v106, 16, v134
    v_and_b32 v107, s51, v134
    v_pk_add_f32 v[90:91], v[90:91], v[54:55]
    v_pk_add_f32 v[92:93], v[92:93], v[56:57]
    v_pk_add_f32 v[94:95], v[94:95], v[58:59]
    v_pk_add_f32 v[96:97], v[96:97], v[60:61]
    v_pk_add_f32 v[98:99], v[98:99], v[62:63]
    v_pk_add_f32 v[100:101], v[100:101], v[64:65]
    v_pk_add_f32 v[102:103], v[102:103], v[66:67]
    v_pk_add_f32 v[104:105], v[104:105], v[68:69]
    v_pk_add_f32 v[106:107], v[106:107], v[70:71]
    v_cvt_pk_bf16_f32 v126, v90, v91
    v_cvt_pk_bf16_f32 v127, v92, v93
    v_cvt_pk_bf16_f32 v128, v94, v95
    v_cvt_pk_bf16_f32 v129, v96, v97
    v_cvt_pk_bf16_f32 v130, v98, v99
    v_cvt_pk_bf16_f32 v131, v100, v101
    v_cvt_pk_bf16_f32 v132, v102, v103
    v_cvt_pk_bf16_f32 v133, v104, v105
    v_cvt_pk_bf16_f32 v134, v106, v107
    v_lshlrev_b32 v90, 16, v126
    v_and_b32 v91, s51, v126
    v_lshlrev_b32 v92, 16, v127
    v_and_b32 v93, s51, v127
    v_lshlrev_b32 v94, 16, v128
    v_and_b32 v95, s51, v128
    v_lshlrev_b32 v96, 16, v129
    v_and_b32 v97, s51, v129
    v_lshlrev_b32 v98, 16, v130
    v_and_b32 v99, s51, v130
    v_lshlrev_b32 v100, 16, v131
    v_and_b32 v101, s51, v131
    v_lshlrev_b32 v102, 16, v132
    v_and_b32 v103, s51, v132
    v_lshlrev_b32 v104, 16, v133
    v_and_b32 v105, s51, v133
    v_lshlrev_b32 v106, 16, v134
    v_and_b32 v107, s51, v134
    v_pk_mul_f32 v[108:109], v[90:91], v[90:91]
    v_pk_mul_f32 v[110:111], v[92:93], v[92:93]
    v_pk_mul_f32 v[112:113], v[94:95], v[94:95]
    v_pk_mul_f32 v[114:115], v[96:97], v[96:97]
    v_pk_mul_f32 v[116:117], v[98:99], v[98:99]
    v_pk_mul_f32 v[118:119], v[100:101], v[100:101]
    v_pk_mul_f32 v[120:121], v[102:103], v[102:103]
    v_pk_mul_f32 v[122:123], v[104:105], v[104:105]
    v_pk_mul_f32 v[124:125], v[106:107], v[106:107]
    v_fma_f32 v108, v108, s58, v136
    v_fma_f32 v109, v109, s58, v136
    v_fma_f32 v110, v110, s58, v136
    v_fma_f32 v111, v111, s58, v136
    v_fma_f32 v112, v112, s58, v136
    v_fma_f32 v113, v113, s58, v136
    v_fma_f32 v114, v114, s58, v136
    v_fma_f32 v115, v115, s58, v136
    v_fma_f32 v116, v116, s58, v136
    v_fma_f32 v117, v117, s58, v136
    v_fma_f32 v118, v118, s58, v136
    v_fma_f32 v119, v119, s58, v136
    v_fma_f32 v120, v120, s58, v136
    v_fma_f32 v121, v121, s58, v136
    v_fma_f32 v122, v122, s58, v136
    v_fma_f32 v123, v123, s58, v136
    v_fma_f32 v124, v124, s58, v136
    v_fma_f32 v125, v125, s58, v136
    v_pk_mul_f32 v[108:109], v[108:109], v[90:91]
    v_pk_mul_f32 v[110:111], v[110:111], v[92:93]
    v_pk_mul_f32 v[112:113], v[112:113], v[94:95]
    v_pk_mul_f32 v[114:115], v[114:115], v[96:97]
    v_pk_mul_f32 v[116:117], v[116:117], v[98:99]
    v_pk_mul_f32 v[118:119], v[118:119], v[100:101]
    v_pk_mul_f32 v[120:121], v[120:121], v[102:103]
    v_pk_mul_f32 v[122:123], v[122:123], v[104:105]
    v_pk_mul_f32 v[124:125], v[124:125], v[106:107]
    v_exp_f32 v108, v108
    v_exp_f32 v109, v109
    v_exp_f32 v110, v110
    v_exp_f32 v111, v111
    v_exp_f32 v112, v112
    v_exp_f32 v113, v113
    v_exp_f32 v114, v114
    v_exp_f32 v115, v115
    v_exp_f32 v116, v116
    v_exp_f32 v117, v117
    v_exp_f32 v118, v118
    v_exp_f32 v119, v119
    v_exp_f32 v120, v120
    v_exp_f32 v121, v121
    v_exp_f32 v122, v122
    v_exp_f32 v123, v123
    v_exp_f32 v124, v124
    v_exp_f32 v125, v125
    v_add_f32 v108, 1.0, v108
    v_add_f32 v109, 1.0, v109
    v_add_f32 v110, 1.0, v110
    v_add_f32 v111, 1.0, v111
    v_add_f32 v112, 1.0, v112
    v_add_f32 v113, 1.0, v113
    v_add_f32 v114, 1.0, v114
    v_add_f32 v115, 1.0, v115
    v_add_f32 v116, 1.0, v116
    v_add_f32 v117, 1.0, v117
    v_add_f32 v118, 1.0, v118
    v_add_f32 v119, 1.0, v119
    v_add_f32 v120, 1.0, v120
    v_add_f32 v121, 1.0, v121
    v_add_f32 v122, 1.0, v122
    v_add_f32 v123, 1.0, v123
    v_add_f32 v124, 1.0, v124
    v_add_f32 v125, 1.0, v125
    v_rcp_f32 v108, v108
    v_rcp_f32 v109, v109
    v_rcp_f32 v110, v110
    v_rcp_f32 v111, v111
    v_rcp_f32 v112, v112
    v_rcp_f32 v113, v113
    v_rcp_f32 v114, v114
    v_rcp_f32 v115, v115
    v_rcp_f32 v116, v116
    v_rcp_f32 v117, v117
    v_rcp_f32 v118, v118
    v_rcp_f32 v119, v119
    v_rcp_f32 v120, v120
    v_rcp_f32 v121, v121
    v_rcp_f32 v122, v122
    v_rcp_f32 v123, v123
    v_rcp_f32 v124, v124
    v_rcp_f32 v125, v125
    v_pk_mul_f32 v[108:109], v[108:109], v[90:91]
    v_pk_mul_f32 v[110:111], v[110:111], v[92:93]
    v_pk_mul_f32 v[112:113], v[112:113], v[94:95]
    v_pk_mul_f32 v[114:115], v[114:115], v[96:97]
    v_pk_mul_f32 v[116:117], v[116:117], v[98:99]
    v_pk_mul_f32 v[118:119], v[118:119], v[100:101]
    v_pk_mul_f32 v[120:121], v[120:121], v[102:103]
    v_pk_mul_f32 v[122:123], v[122:123], v[104:105]
    v_pk_mul_f32 v[124:125], v[124:125], v[106:107]
    v_cvt_pk_bf16_f32 v126, v108, v109
    v_cvt_pk_bf16_f32 v127, v110, v111
    v_cvt_pk_bf16_f32 v128, v112, v113
    v_cvt_pk_bf16_f32 v129, v114, v115
    v_cvt_pk_bf16_f32 v130, v116, v117
    v_cvt_pk_bf16_f32 v131, v118, v119
    v_cvt_pk_bf16_f32 v132, v120, v121
    v_cvt_pk_bf16_f32 v133, v122, v123
    v_cvt_pk_bf16_f32 v134, v124, v125
    v_lshlrev_b32 v108, 16, v126
    v_and_b32 v109, s51, v126
    v_lshlrev_b32 v110, 16, v127
    v_and_b32 v111, s51, v127
    v_lshlrev_b32 v112, 16, v128
    v_and_b32 v113, s51, v128
    v_lshlrev_b32 v114, 16, v129
    v_and_b32 v115, s51, v129
    v_lshlrev_b32 v116, 16, v130
    v_and_b32 v117, s51, v130
    v_lshlrev_b32 v118, 16, v131
    v_and_b32 v119, s51, v131
    v_lshlrev_b32 v120, 16, v132
    v_and_b32 v121, s51, v132
    v_lshlrev_b32 v122, 16, v133
    v_and_b32 v123, s51, v133
    v_lshlrev_b32 v124, 16, v134
    v_and_b32 v125, s51, v134
    v_pk_mul_f32 v[90:91], v[108:109], v[72:73]
    v_pk_fma_f32 v[90:91], v[110:111], v[74:75], v[90:91]
    v_pk_fma_f32 v[90:91], v[112:113], v[76:77], v[90:91]
    v_pk_fma_f32 v[90:91], v[114:115], v[78:79], v[90:91]
    v_pk_fma_f32 v[90:91], v[116:117], v[80:81], v[90:91]
    v_pk_fma_f32 v[90:91], v[118:119], v[82:83], v[90:91]
    v_pk_fma_f32 v[90:91], v[120:121], v[84:85], v[90:91]
    v_pk_fma_f32 v[90:91], v[122:123], v[86:87], v[90:91]
    v_pk_fma_f32 v[90:91], v[124:125], v[88:89], v[90:91]
    v_add_f32 v137, v90, v91
    s_nop 1
    v_add_f32_dpp v137, v137, v137 quad_perm:[1,0,3,2] row_mask:0xf bank_mask:0xf
    s_nop 1
    v_add_f32_dpp v137, v137, v137 quad_perm:[2,3,0,1] row_mask:0xf bank_mask:0xf
    s_nop 1
    v_add_f32_dpp v137, v137, v137 row_half_mirror row_mask:0xf bank_mask:0xf
    s_nop 1
    v_add_f32_dpp v137, v137, v137 row_mirror row_mask:0xf bank_mask:0xf
    s_nop 1
    v_add_f32_dpp v137, v137, v137 row_bcast:15 row_mask:0xa bank_mask:0xf
    s_nop 1
    v_add_f32_dpp v137, v137, v137 row_bcast:31 row_mask:0xc bank_mask:0xf
    s_mov_b32 exec_lo, 0
    s_mov_b32 exec_hi, 0x80000000
    ds_write_b32 v166, v137 offset:14848
    s_mov_b64 exec, -1
    v_add_u32 v166, 16, v166
    s_add_u32 s79, s79, 0x10000
    s_sub_u32 s49, s49, 1
    s_cmp_lg_u32 s49, 0
    s_cbranch_scc1 L_tab
    s_setprio 2
    s_mov_b64 exec, 1
    ds_add_u32 v27, v26 offset:776
    s_mov_b64 exec, -1
L_h3:
    s_waitcnt vmcnt(0) lgkmcnt(0)
    s_mov_b64 exec, 0
    s_cmp_eq_u32 s3, 3
    s_cbranch_scc1 L_t2
    s_branch L_t1
L_dryret:
    s_waitcnt lgkmcnt(0)
    s_mov_b64 exec, -1
    v_bfe_u32 v156, v0, 5, 2
    v_lshlrev_b32 v156, 8, v156
    v_bfe_u32 v157, v0, 7, 1
    v_lshl_add_u32 v156, v157, 7, v156
    v_and_b32 v158, 7, v0
    v_lshl_add_u32 v156, v158, 4, v156
    v_bfe_u32 v159, v0, 3, 2
    v_lshl_add_u32 v156, v159, 2, v156
    v_add_u32 v156, 1024, v156
    v_lshlrev_b32 v157, 6, v157
    v_lshl_add_u32 v157, v158, 3, v157
    s_lshr_b32 s56, s2, 3
    s_lshr_b32 s57, s3, 1
    s_lshl1_add_u32 s56, s56, s57
    s_and_b32 s57, s2, 7
    s_lshl3_add_u32 s56, s56, s57
    s_mul_i32 s56, s56, 640
    s_add_u32 s56, s56, 589824
    v_and_b32 v158, 127, v0
    v_lshl_add_u32 v158, v158, 2, s56
    v_mov_b32 v159, s56
    s_cmp_lg_u32 s3, 1
    s_cbranch_scc1 L_egw
L_tw:
    ds_read_b32 v164, v27 offset:776
    s_waitcnt lgkmcnt(0)
    v_cmp_ne_u32 vcc, 4, v164
    s_sleep 2
    s_sub_u32 s77, s77, 1
    s_cbranch_scc1 L_end
    s_cbranch_vccnz L_tw
    v_min_u32 v208, 3, v1
    v_mul_u32_u24 v209, 96, v208
    ds_read_b128 v[172:175], v209 offset:14848
    ds_read_b128 v[176:179], v209 offset:14864
    ds_read_b128 v[180:183], v209 offset:14880
    ds_read_b128 v[184:187], v209 offset:14896
    ds_read_b128 v[188:191], v209 offset:14912
    ds_read_b128 v[192:195], v209 offset:14928
    s_lshl_b32 s56, s2, 8
    s_add_u32 s56, s56, 1048768
    v_lshl_add_u32 v208, v208, 4, s56
    s_waitcnt lgkmcnt(0)
    v_pk_add_f32 v[172:173], v[172:173], v[174:175]
    v_pk_add_f32 v[176:177], v[176:177], v[178:179]
    v_pk_add_f32 v[180:181], v[180:181], v[182:183]
    v_pk_add_f32 v[184:185], v[184:185], v[186:187]
    v_pk_add_f32 v[188:189], v[188:189], v[190:191]
    v_pk_add_f32 v[192:193], v[192:193], v[194:195]
    v_add_f32 v196, v172, v173
    v_add_f32 v197, v176, v177
    v_add_f32 v198, v180, v181
    v_add_f32 v199, v184, v185
    v_add_f32 v200, v188, v189
    v_add_f32 v201, v192, v193
    v_cvt_pk_bf16_f32 v204, v196, v197
    v_cvt_pk_bf16_f32 v205, v198, v199
    v_cvt_pk_bf16_f32 v206, v200, v201
    v_lshlrev_b32 v196, 16, v204
    v_and_b32 v197, s51, v204
    v_lshlrev_b32 v198, 16, v205
    v_and_b32 v199, s51, v205
    v_lshlrev_b32 v200, 16, v206
    v_and_b32 v201, s51, v206
    v_add_f32 v196, v196, v24
    v_add_f32 v197, v197, v24
    v_add_f32 v198, v198, v24
    v_add_f32 v199, v199, v24
    v_add_f32 v200, v200, v24
    v_add_f32 v201, v201, v24
    v_cvt_pk_bf16_f32 v204, v196, v197
    v_cvt_pk_bf16_f32 v205, v198, v199
    v_cvt_pk_bf16_f32 v206, v200, v201
    v_mov_b32 v207, s50
    s_mov_b64 s[72:73], 15
    s_and_b32 s60, s2, 7
    s_and_b32 s56, s2, 0xf8
    s_lshl_b32 s56, s56, 8
    s_add_u32 s63, s56, 1048704
    v_and_b32 v171, 7, v1
    s_mov_b32 s74, 0x381a2200
    s_mov_b32 s75, 0x2301391b
    v_xor_b32 v176, s60, v171
    v_lshlrev_b32 v176, 3, v176
    v_lshrrev_b64 v[176:177], v176, s[74:75]
    v_and_b32 v176, 0xff, v176
    v_lshlrev_b32 v176, 12, v176
    v_xor_b32 v176, s30, v176
    v_lshl_add_u32 v171, v171, 8, s63
    s_mov_b32 s49, 0
    s_cmp_ge_u32 s78, 9
    s_cselect_b32 s76, 8, 0
L_tr0:
    ds_read_b32 v172, v27 offset:780
    s_waitcnt lgkmcnt(0)
    v_readfirstlane_b32 s56, v172
    s_ashr_i32 s57, s56, 1
    s_max_i32 s56, s56, s57
    s_add_u32 s56, s56, 28
    s_add_u32 s56, s56, s76
    s_cmp_ge_i32 s56, s49
    s_cbranch_scc1 L_tg0
    s_sleep 1
    s_sub_u32 s77, s77, 1
    s_cbranch_scc1 L_end
    s_branch L_tr0
L_tg0:
    global_load_dwordx2 v[166:167], v171, s[28:29] sc1
    s_waitcnt vmcnt(0)
    v_cmp_eq_u32 vcc, s50, v167
    s_nop 1
    v_cndmask_b32 v166, -1, v166, vcc
L_srv:
    v_min_u32 v174, 12, v166
    v_cmp_ge_u32 vcc, 4, v166
    v_readlane_b32 s57, v166, s60
    v_add_u32_dpp v174, v174, v174 quad_perm:[1,0,3,2] row_mask:0xf bank_mask:0xf
    s_nop 1
    v_add_u32_dpp v174, v174, v174 quad_perm:[2,3,0,1] row_mask:0xf bank_mask:0xf
    s_nop 1
    v_add_u32_dpp v174, v174, v174 row_half_mirror row_mask:0xf bank_mask:0xf
    s_nop 1
    v_readfirstlane_b32 s62, v174
    v_lshl_add_u32 v173, v1, 2, s49
    s_mov_b32 s61, s60
    s_cmp_lt_u32 s57, 12
    s_cbranch_scc1 L_sel
    s_and_b32 s56, vcc_lo, 0xff
    s_cbranch_scc0 L_cls
    s_mul_i32 s56, s56, 0x01010101
    s_mov_b32 s57, s56
    s_mov_b32 s58, s60
L_pick:
    s_ff1_i32_b64 s61, s[56:57]
    s_bitset0_b64 s[56:57], s61
    s_sub_u32 s58, s58, 1
    s_cbranch_scc0 L_pick
    s_and_b32 s61, s61, 7
L_sel:
    v_readlane_b32 s56, v166, s61
    s_cmp_le_i32 s62, 48
    s_cselect_b32 s57, 8, 4
    s_cmp_lt_i32 s62, 32
    s_cselect_b32 s62, 16, s57
    s_sub_u32 s56, 12, s56
    s_min_u32 s62, s62, s56
L_req:
    s_lshl_b32 s56, s61, 8
    s_add_u32 s56, s56, s63
    v_mov_b32 v169, s56
    v_mov_b32 v170, s62
L_tr1:
    ds_read_b32 v172, v27 offset:780
    s_waitcnt lgkmcnt(0)
    v_readfirstlane_b32 s56, v172
    s_ashr_i32 s57, s56, 1
    s_max_i32 s56, s56, s57
    s_add_u32 s56, s56, 12
    s_add_u32 s56, s56, s76
    s_cmp_ge_i32 s56, s49
    s_cbranch_scc1 L_tg1
    s_sleep 1
    s_sub_u32 s77, s77, 1
    s_cbranch_scc1 L_end
    s_branch L_tr1
L_tg1:
    s_mov_b64 exec, s[72:73]
    s_cbranch_execz L_sk8
    global_store_dwordx4 v208, v[204:207], s[28:29] sc1
    s_mov_b64 s[72:73], 0
L_sk8:
    s_mov_b64 exec, 1
    global_atomic_add v168, v169, v170, s[28:29] sc0 sc1
    s_mov_b64 exec, -1
    s_cmp_gt_u32 s62, 4
    s_cbranch_scc1 L_ns
    global_load_dwordx2 v[166:167], v171, s[28:29] sc1
L_ns:
    s_waitcnt vmcnt(0)
    v_cmp_eq_u32 vcc, s50, v167
    s_nop 1
    v_cndmask_b32 v166, -1, v166, vcc
    v_readfirstlane_b32 s56, v168
    s_mov_b32 m0, s61
    s_lshl_b32 s61, s61, 8
    s_add_u32 s61, s61, 238
    s_add_u32 s57, s56, s62
    s_min_u32 s58, s57, 12
    s_min_u32 s56, s56, 12
    s_add_u32 s61, s61, s56
    s_sub_u32 s58, s58, s56
    v_readlane_b32 s56, v176, m0
    v_add_lshl_u32 v172, v1, s61, 12
    s_nop 0
    v_xor_b32 v172, s56, v172
    s_bfm_b64 exec, s58, 0
    ds_write_b32 v173, v172 offset:16384
    s_mov_b64 exec, -1
    s_lshl2_add_u32 s49, s58, s49
    s_cmp_gt_u32 s62, 4
    s_cbranch_scc1 L_tr0
    v_readlane_b32 s58, v166, m0
    s_max_u32 s58, s58, s57
    s_nop 0
    v_writelane_b32 v166, s58, m0
    s_branch L_srv
L_cls:
    v_cmp_ne_u32 vcc, s50, v167
    s_sub_u32 s77, s77, 16
    s_cbranch_scc1 L_end
    s_cbranch_vccnz L_tr0
    s_add_u32 s56, s63, 8
    v_mov_b32 v169, s56
L_cl2:
L_tr2:
    ds_read_b32 v172, v27 offset:780
    s_waitcnt lgkmcnt(0)
    v_readfirstlane_b32 s56, v172
    s_ashr_i32 s57, s56, 1
    s_max_i32 s56, s56, s57
    s_add_u32 s56, s56, 12
    s_add_u32 s56, s56, s76
    s_cmp_ge_i32 s56, s49
    s_cbranch_scc1 L_tg2
    s_sleep 1
    s_sub_u32 s77, s77, 1
    s_cbranch_scc1 L_end
    s_branch L_tr2
L_tg2:
    s_mov_b64 exec, s[72:73]
    s_cbranch_execz L_sk9
    global_store_dwordx4 v208, v[204:207], s[28:29] sc1
    s_mov_b64 s[72:73], 0
L_sk9:
    s_mov_b64 exec, 1
    global_atomic_add v168, v169, v26, s[28:29] sc0 sc1
    s_mov_b64 exec, -1
    v_lshl_add_u32 v173, v1, 2, s49
    s_mov_b32 s58, 0xa070400
    s_mov_b32 s59, 0x100f0e0c
    s_waitcnt vmcnt(0)
    v_readfirstlane_b32 s56, v168
    s_sub_u32 s57, s56, 8
    s_and_b32 s57, s57, 7
    s_lshl_b32 s61, s57, 3
    s_lshr_b64 s[58:59], s[58:59], s61
    s_and_b32 s58, s58, 0xff
    s_add_u32 s58, s58, 32
    s_lshl_b32 s57, s57, 2
    s_lshr_b32 s62, 0x1122334, s57
    s_and_b32 s62, s62, 15
    s_mul_i32 s57, s56, 4
    s_cmp_lt_u32 s56, 8
    s_cselect_b32 s58, s57, s58
    s_cselect_b32 s62, 4, s62
    v_add_u32 v172, s58, v1
    v_bfe_u32 v174, v172, 0, 3
    v_lshrrev_b32 v175, 3, v172
    v_bfi_b32 v172, 0, v172, v175
    v_lshl_add_u32 v172, v174, 8, v172
    v_add_u32 v172, 250, v172
    v_lshlrev_b32 v172, 12, v172
    v_xor_b32 v176, s60, v174
    v_lshlrev_b32 v176, 3, v176
    v_lshrrev_b64 v[176:177], v176, s[74:75]
    v_and_b32 v176, 0xff, v176
    v_lshlrev_b32 v176, 12, v176
    v_xor_b32 v176, s30, v176
    v_xor_b32 v172, v172, v176
    s_bfm_b64 exec, s62, 0
    ds_write_b32 v173, v172 offset:16384
    s_mov_b64 exec, -1
    s_lshl2_add_u32 s49, s62, s49
    s_cmp_lt_u32 s56, 8
    s_cbranch_scc1 L_cl2
    v_lshl_add_u32 v173, v1, 2, s49
    v_mov_b32 v175, -2
    s_mov_b64 exec, 0xff
    ds_write_b32 v173, v175 offset:16384
    s_mov_b64 exec, -1
    ds_write_b32 v27, v26 offset:784
L_egw:
    ds_read2_b32 v[172:173], v27 offset0:195 offset1:196
    s_waitcnt lgkmcnt(0)
    v_readfirstlane_b32 s56, v172
    v_readfirstlane_b32 s57, v173
    s_cmp_ge_i32 s56, 0
    s_cselect_b32 s57, s57, 0
    s_cmp_lg_u32 s57, 0
    s_cbranch_scc1 L_ego
    s_sleep 2
    s_sub_u32 s77, s77, 1
    s_cbranch_scc1 L_end
    s_branch L_egw
L_ego:
    s_cmp_eq_u32 s3, 0
    s_cbranch_scc1 L_fw
    s_mov_b64 exec, 1
    ds_add_rtn_u32 v179, v27, v25 offset:780
    s_mov_b64 exec, -1
    s_waitcnt lgkmcnt(0)
    v_and_b32 v174, 0x7fc, v179
    ds_read_b32 v175, v174 offset:16384
L_rsc:
    s_waitcnt lgkmcnt(0)
    v_readfirstlane_b32 s31, v175
    s_cmp_lg_u32 s31, -1
    s_cbranch_scc1 L_rkc
    ds_read_b32 v175, v174 offset:16384
    s_sub_u32 s77, s77, 1
    s_cbranch_scc1 L_end
    s_branch L_rsc
L_rkc:
    s_cmp_eq_u32 s31, -2
    s_cbranch_scc1 L_fw
    s_mov_b32 s14, s31
    buffer_load_dwordx4 v[212:215], v2, s[32:35], s14 offen offset:0 nt
    buffer_load_dwordx4 v[216:219], v2, s[32:35], s14 offen offset:1024 nt
    buffer_load_dwordx4 v[220:223], v2, s[32:35], s14 offen offset:2048 nt
    buffer_load_dwordx4 v[224:227], v2, s[32:35], s14 offen offset:3072 nt
    s_branch L_vref
L_fb:
L_fb0:
    s_mov_b32 s76, -1
    v_cmp_le_u32 vcc, 6144, v182
    s_ff1_i32_b64 s56, vcc
    s_cmp_lt_i32 s56, 0
    s_cbranch_scc1 L_fn0
    v_readlane_b32 s76, v214, s56
L_fn0:
    v_cmp_le_u32 vcc, 6144, v183
    s_ff1_i32_b64 s56, vcc
    s_cmp_lt_i32 s56, 0
    s_cbranch_scc1 L_fn1
    v_readlane_b32 s76, v215, s56
L_fn1:
    v_cmp_le_u32 vcc, 6144, v184
    s_ff1_i32_b64 s56, vcc
    s_cmp_lt_i32 s56, 0
    s_cbranch_scc1 L_fn2
    v_readlane_b32 s76, v216, s56
L_fn2:
    v_cmp_le_u32 vcc, 6144, v185
    s_ff1_i32_b64 s56, vcc
    s_cmp_lt_i32 s56, 0
    s_cbranch_scc1 L_fn3
    v_readlane_b32 s76, v217, s56
L_fn3:
    v_cmp_le_u32 vcc, 6144, v186
    s_ff1_i32_b64 s56, vcc
    s_cmp_lt_i32 s56, 0
    s_cbranch_scc1 L_fn4
    v_readlane_b32 s76, v218, s56
L_fn4:
    v_cmp_le_u32 vcc, 6144, v187
    s_ff1_i32_b64 s56, vcc
    s_cmp_lt_i32 s56, 0
    s_cbranch_scc1 L_fn5
    v_readlane_b32 s76, v219, s56
L_fn5:
    v_cmp_le_u32 vcc, 6144, v188
    s_ff1_i32_b64 s56, vcc
    s_cmp_lt_i32 s56, 0
    s_cbranch_scc1 L_fn6
    v_readlane_b32 s76, v220, s56
L_fn6:
    v_cmp_le_u32 vcc, 6144, v189
    s_ff1_i32_b64 s56, vcc
    s_cmp_lt_i32 s56, 0
    s_cbranch_scc1 L_fn7
    v_readlane_b32 s76, v221, s56
L_fn7:
    v_cmp_le_u32 vcc, 6144, v190
    s_ff1_i32_b64 s56, vcc
    s_cmp_lt_i32 s56, 0
    s_cbranch_scc1 L_fn8
    v_readlane_b32 s76, v222, s56
L_fn8:
    s_nop 3
    s_cmp_lt_i32 s76, 0
    s_cbranch_scc1 L_out
    s_lshl_b32 s79, s76, 15
    v_mov_b32 v236, v3
    v_lshlrev_b32 v237, 2, v1
    v_mov_b32 v238, 0
    s_mov_b32 s49, 4
L_ev:
    global_load_dwordx4 v[128:131], v236, s[16:17] offset:0
    global_load_dwordx4 v[132:135], v236, s[16:17] offset:1024
    global_load_dword v136, v237, s[16:17] offset:2048
    global_load_dwordx4 v[140:143], v236, s[18:19] offset:0
    global_load_dwordx4 v[144:147], v236, s[18:19] offset:1024
    global_load_dword v148, v237, s[18:19] offset:2048
    global_load_dwordx4 v[152:155], v236, s[20:21] offset:0
    global_load_dwordx4 v[156:159], v236, s[20:21] offset:1024
    global_load_dword v160, v237, s[20:21] offset:2048
    s_waitcnt vmcnt(0)
    v_lshlrev_b32 v36, 16, v128
    v_and_b32 v37, s51, v128
    v_lshlrev_b32 v38, 16, v129
    v_and_b32 v39, s51, v129
    v_lshlrev_b32 v40, 16, v130
    v_and_b32 v41, s51, v130
    v_lshlrev_b32 v42, 16, v131
    v_and_b32 v43, s51, v131
    v_lshlrev_b32 v44, 16, v132
    v_and_b32 v45, s51, v132
    v_lshlrev_b32 v46, 16, v133
    v_and_b32 v47, s51, v133
    v_lshlrev_b32 v48, 16, v134
    v_and_b32 v49, s51, v134
    v_lshlrev_b32 v50, 16, v135
    v_and_b32 v51, s51, v135
    v_lshlrev_b32 v52, 16, v136
    v_and_b32 v53, s51, v136
    v_lshlrev_b32 v54, 16, v140
    v_and_b32 v55, s51, v140
    v_lshlrev_b32 v56, 16, v141
    v_and_b32 v57, s51, v141
    v_lshlrev_b32 v58, 16, v142
    v_and_b32 v59, s51, v142
    v_lshlrev_b32 v60, 16, v143
    v_and_b32 v61, s51, v143
    v_lshlrev_b32 v62, 16, v144
    v_and_b32 v63, s51, v144
    v_lshlrev_b32 v64, 16, v145
    v_and_b32 v65, s51, v145
    v_lshlrev_b32 v66, 16, v146
    v_and_b32 v67, s51, v146
    v_lshlrev_b32 v68, 16, v147
    v_and_b32 v69, s51, v147
    v_lshlrev_b32 v70, 16, v148
    v_and_b32 v71, s51, v148
    v_lshlrev_b32 v72, 16, v152
    v_and_b32 v73, s51, v152
    v_lshlrev_b32 v74, 16, v153
    v_and_b32 v75, s51, v153
    v_lshlrev_b32 v76, 16, v154
    v_and_b32 v77, s51, v154
    v_lshlrev_b32 v78, 16, v155
    v_and_b32 v79, s51, v155
    v_lshlrev_b32 v80, 16, v156
    v_and_b32 v81, s51, v156
    v_lshlrev_b32 v82, 16, v157
    v_and_b32 v83, s51, v157
    v_lshlrev_b32 v84, 16, v158
    v_and_b32 v85, s51, v158
    v_lshlrev_b32 v86, 16, v159
    v_and_b32 v87, s51, v159
    v_lshlrev_b32 v88, 16, v160
    v_and_b32 v89, s51, v160
    v_mov_b32 v136, 0xc0135761
    s_mov_b32 s58, 0xbdd2d3e8
    v_mul_f32 v90, s79, v36
    v_mul_f32 v91, s79, v37
    v_mul_f32 v92, s79, v38
    v_mul_f32 v93, s79, v39
    v_mul_f32 v94, s79, v40
    v_mul_f32 v95, s79, v41
    v_mul_f32 v96, s79, v42
    v_mul_f32 v97, s79, v43
    v_mul_f32 v98, s79, v44
    v_mul_f32 v99, s79, v45
    v_mul_f32 v100, s79, v46
    v_mul_f32 v101, s79, v47
    v_mul_f32 v102, s79, v48
    v_mul_f32 v103, s79, v49
    v_mul_f32 v104, s79, v50
    v_mul_f32 v105, s79, v51
    v_mul_f32 v106, s79, v52
    v_mul_f32 v107, s79, v53
    v_cvt_pk_bf16_f32 v126, v90, v91
    v_cvt_pk_bf16_f32 v127, v92, v93
    v_cvt_pk_bf16_f32 v128, v94, v95
    v_cvt_pk_bf16_f32 v129, v96, v97
    v_cvt_pk_bf16_f32 v130, v98, v99
    v_cvt_pk_bf16_f32 v131, v100, v101
    v_cvt_pk_bf16_f32 v132, v102, v103
    v_cvt_pk_bf16_f32 v133, v104, v105
    v_cvt_pk_bf16_f32 v134, v106, v107
    v_lshlrev_b32 v90, 16, v126
    v_and_b32 v91, s51, v126
    v_lshlrev_b32 v92, 16, v127
    v_and_b32 v93, s51, v127
    v_lshlrev_b32 v94, 16, v128
    v_and_b32 v95, s51, v128
    v_lshlrev_b32 v96, 16, v129
    v_and_b32 v97, s51, v129
    v_lshlrev_b32 v98, 16, v130
    v_and_b32 v99, s51, v130
    v_lshlrev_b32 v100, 16, v131
    v_and_b32 v101, s51, v131
    v_lshlrev_b32 v102, 16, v132
    v_and_b32 v103, s51, v132
    v_lshlrev_b32 v104, 16, v133
    v_and_b32 v105, s51, v133
    v_lshlrev_b32 v106, 16, v134
    v_and_b32 v107, s51, v134
    v_pk_add_f32 v[90:91], v[90:91], v[54:55]
    v_pk_add_f32 v[92:93], v[92:93], v[56:57]
    v_pk_add_f32 v[94:95], v[94:95], v[58:59]
    v_pk_add_f32 v[96:97], v[96:97], v[60:61]
    v_pk_add_f32 v[98:99], v[98:99], v[62:63]
    v_pk_add_f32 v[100:101], v[100:101], v[64:65]
    v_pk_add_f32 v[102:103], v[102:103], v[66:67]
    v_pk_add_f32 v[104:105], v[104:105], v[68:69]
    v_pk_add_f32 v[106:107], v[106:107], v[70:71]
    v_cvt_pk_bf16_f32 v126, v90, v91
    v_cvt_pk_bf16_f32 v127, v92, v93
    v_cvt_pk_bf16_f32 v128, v94, v95
    v_cvt_pk_bf16_f32 v129, v96, v97
    v_cvt_pk_bf16_f32 v130, v98, v99
    v_cvt_pk_bf16_f32 v131, v100, v101
    v_cvt_pk_bf16_f32 v132, v102, v103
    v_cvt_pk_bf16_f32 v133, v104, v105
    v_cvt_pk_bf16_f32 v134, v106, v107
    v_lshlrev_b32 v90, 16, v126
    v_and_b32 v91, s51, v126
    v_lshlrev_b32 v92, 16, v127
    v_and_b32 v93, s51, v127
    v_lshlrev_b32 v94, 16, v128
    v_and_b32 v95, s51, v128
    v_lshlrev_b32 v96, 16, v129
    v_and_b32 v97, s51, v129
    v_lshlrev_b32 v98, 16, v130
    v_and_b32 v99, s51, v130
    v_lshlrev_b32 v100, 16, v131
    v_and_b32 v101, s51, v131
    v_lshlrev_b32 v102, 16, v132
    v_and_b32 v103, s51, v132
    v_lshlrev_b32 v104, 16, v133
    v_and_b32 v105, s51, v133
    v_lshlrev_b32 v106, 16, v134
    v_and_b32 v107, s51, v134
    v_pk_mul_f32 v[108:109], v[90:91], v[90:91]
    v_pk_mul_f32 v[110:111], v[92:93], v[92:93]
    v_pk_mul_f32 v[112:113], v[94:95], v[94:95]
    v_pk_mul_f32 v[114:115], v[96:97], v[96:97]
    v_pk_mul_f32 v[116:117], v[98:99], v[98:99]
    v_pk_mul_f32 v[118:119], v[100:101], v[100:101]
    v_pk_mul_f32 v[120:121], v[102:103], v[102:103]
    v_pk_mul_f32 v[122:123], v[104:105], v[104:105]
    v_pk_mul_f32 v[124:125], v[106:107], v[106:107]
    v_fma_f32 v108, v108, s58, v136
    v_fma_f32 v109, v109, s58, v136
    v_fma_f32 v110, v110, s58, v136
    v_fma_f32 v111, v111, s58, v136
    v_fma_f32 v112, v112, s58, v136
    v_fma_f32 v113, v113, s58, v136
    v_fma_f32 v114, v114, s58, v136
    v_fma_f32 v115, v115, s58, v136
    v_fma_f32 v116, v116, s58, v136
    v_fma_f32 v117, v117, s58, v136
    v_fma_f32 v118, v118, s58, v136
    v_fma_f32 v119, v119, s58, v136
    v_fma_f32 v120, v120, s58, v136
    v_fma_f32 v121, v121, s58, v136
    v_fma_f32 v122, v122, s58, v136
    v_fma_f32 v123, v123, s58, v136
    v_fma_f32 v124, v124, s58, v136
    v_fma_f32 v125, v125, s58, v136
    v_pk_mul_f32 v[108:109], v[108:109], v[90:91]
    v_pk_mul_f32 v[110:111], v[110:111], v[92:93]
    v_pk_mul_f32 v[112:113], v[112:113], v[94:95]
    v_pk_mul_f32 v[114:115], v[114:115], v[96:97]
    v_pk_mul_f32 v[116:117], v[116:117], v[98:99]
    v_pk_mul_f32 v[118:119], v[118:119], v[100:101]
    v_pk_mul_f32 v[120:121], v[120:121], v[102:103]
    v_pk_mul_f32 v[122:123], v[122:123], v[104:105]
    v_pk_mul_f32 v[124:125], v[124:125], v[106:107]
    v_exp_f32 v108, v108
    v_exp_f32 v109, v109
    v_exp_f32 v110, v110
    v_exp_f32 v111, v111
    v_exp_f32 v112, v112
    v_exp_f32 v113, v113
    v_exp_f32 v114, v114
    v_exp_f32 v115, v115
    v_exp_f32 v116, v116
    v_exp_f32 v117, v117
    v_exp_f32 v118, v118
    v_exp_f32 v119, v119
    v_exp_f32 v120, v120
    v_exp_f32 v121, v121
    v_exp_f32 v122, v122
    v_exp_f32 v123, v123
    v_exp_f32 v124, v124
    v_exp_f32 v125, v125
    v_add_f32 v108, 1.0, v108
    v_add_f32 v109, 1.0, v109
    v_add_f32 v110, 1.0, v110
    v_add_f32 v111, 1.0, v111
    v_add_f32 v112, 1.0, v112
    v_add_f32 v113, 1.0, v113
    v_add_f32 v114, 1.0, v114
    v_add_f32 v115, 1.0, v115
    v_add_f32 v116, 1.0, v116
    v_add_f32 v117, 1.0, v117
    v_add_f32 v118, 1.0, v118
    v_add_f32 v119, 1.0, v119
    v_add_f32 v120, 1.0, v120
    v_add_f32 v121, 1.0, v121
    v_add_f32 v122, 1.0, v122
    v_add_f32 v123, 1.0, v123
    v_add_f32 v124, 1.0, v124
    v_add_f32 v125, 1.0, v125
    v_rcp_f32 v108, v108
    v_rcp_f32 v109, v109
    v_rcp_f32 v110, v110
    v_rcp_f32 v111, v111
    v_rcp_f32 v112, v112
    v_rcp_f32 v113, v113
    v_rcp_f32 v114, v114
    v_rcp_f32 v115, v115
    v_rcp_f32 v116, v116
    v_rcp_f32 v117, v117
    v_rcp_f32 v118, v118
    v_rcp_f32 v119, v119
    v_rcp_f32 v120, v120
    v_rcp_f32 v121, v121
    v_rcp_f32 v122, v122
    v_rcp_f32 v123, v123
    v_rcp_f32 v124, v124
    v_rcp_f32 v125, v125
    v_pk_mul_f32 v[108:109], v[108:109], v[90:91]
    v_pk_mul_f32 v[110:111], v[110:111], v[92:93]
    v_pk_mul_f32 v[112:113], v[112:113], v[94:95]
    v_pk_mul_f32 v[114:115], v[114:115], v[96:97]
    v_pk_mul_f32 v[116:117], v[116:117], v[98:99]
    v_pk_mul_f32 v[118:119], v[118:119], v[100:101]
    v_pk_mul_f32 v[120:121], v[120:121], v[102:103]
    v_pk_mul_f32 v[122:123], v[122:123], v[104:105]
    v_pk_mul_f32 v[124:125], v[124:125], v[106:107]
    v_cvt_pk_bf16_f32 v126, v108, v109
    v_cvt_pk_bf16_f32 v127, v110, v111
    v_cvt_pk_bf16_f32 v128, v112, v113
    v_cvt_pk_bf16_f32 v129, v114, v115
    v_cvt_pk_bf16_f32 v130, v116, v117
    v_cvt_pk_bf16_f32 v131, v118, v119
    v_cvt_pk_bf16_f32 v132, v120, v121
    v_cvt_pk_bf16_f32 v133, v122, v123
    v_cvt_pk_bf16_f32 v134, v124, v125
    v_lshlrev_b32 v108, 16, v126
    v_and_b32 v109, s51, v126
    v_lshlrev_b32 v110, 16, v127
    v_and_b32 v111, s51, v127
    v_lshlrev_b32 v112, 16, v128
    v_and_b32 v113, s51, v128
    v_lshlrev_b32 v114, 16, v129
    v_and_b32 v115, s51, v129
    v_lshlrev_b32 v116, 16, v130
    v_and_b32 v117, s51, v130
    v_lshlrev_b32 v118, 16, v131
    v_and_b32 v119, s51, v131
    v_lshlrev_b32 v120, 16, v132
    v_and_b32 v121, s51, v132
    v_lshlrev_b32 v122, 16, v133
    v_and_b32 v123, s51, v133
    v_lshlrev_b32 v124, 16, v134
    v_and_b32 v125, s51, v134
    v_pk_mul_f32 v[90:91], v[108:109], v[72:73]
    v_pk_fma_f32 v[90:91], v[110:111], v[74:75], v[90:91]
    v_pk_fma_f32 v[90:91], v[112:113], v[76:77], v[90:91]
    v_pk_fma_f32 v[90:91], v[114:115], v[78:79], v[90:91]
    v_pk_fma_f32 v[90:91], v[116:117], v[80:81], v[90:91]
    v_pk_fma_f32 v[90:91], v[118:119], v[82:83], v[90:91]
    v_pk_fma_f32 v[90:91], v[120:121], v[84:85], v[90:91]
    v_pk_fma_f32 v[90:91], v[122:123], v[86:87], v[90:91]
    v_pk_fma_f32 v[90:91], v[124:125], v[88:89], v[90:91]
    v_add_f32 v90, v90, v91
    v_add_f32 v238, v238, v90
    v_add_u32 v236, 2304, v236
    v_add_u32 v237, 2304, v237
    s_sub_u32 s49, s49, 1
    s_cmp_lg_u32 s49, 0
    s_cbranch_scc1 L_ev
    s_nop 1
    v_add_f32_dpp v238, v238, v238 quad_perm:[1,0,3,2] row_mask:0xf bank_mask:0xf
    s_nop 1
    v_add_f32_dpp v238, v238, v238 quad_perm:[2,3,0,1] row_mask:0xf bank_mask:0xf
    s_nop 1
    v_add_f32_dpp v238, v238, v238 row_half_mirror row_mask:0xf bank_mask:0xf
    s_nop 1
    v_add_f32_dpp v238, v238, v238 row_mirror row_mask:0xf bank_mask:0xf
    s_nop 1
    v_add_f32_dpp v238, v238, v238 row_bcast:15 row_mask:0xa bank_mask:0xf
    s_nop 1
    v_add_f32_dpp v238, v238, v238 row_bcast:31 row_mask:0xc bank_mask:0xf
    v_cvt_pk_bf16_f32 v238, v238, v238
    v_and_b32 v238, s51, v238
    v_add_f32 v238, v238, v24
    v_cvt_pk_bf16_f32 v238, v238, v238
    v_and_b32 v238, s51, v238
    s_nop 0
    v_readlane_b32 s56, v238, 63
    s_nop 1
    v_mov_b32 v238, s56
    v_cmp_eq_u32 vcc, s76, v214
    s_nop 1
    v_cndmask_b32 v204, v204, v238, vcc
    v_cndmask_b32 v182, v182, v27, vcc
    v_cmp_eq_u32 vcc, s76, v215
    s_nop 1
    v_cndmask_b32 v205, v205, v238, vcc
    v_cndmask_b32 v183, v183, v27, vcc
    v_cmp_eq_u32 vcc, s76, v216
    s_nop 1
    v_cndmask_b32 v206, v206, v238, vcc
    v_cndmask_b32 v184, v184, v27, vcc
    v_cmp_eq_u32 vcc, s76, v217
    s_nop 1
    v_cndmask_b32 v207, v207, v238, vcc
    v_cndmask_b32 v185, v185, v27, vcc
    v_cmp_eq_u32 vcc, s76, v218
    s_nop 1
    v_cndmask_b32 v208, v208, v238, vcc
    v_cndmask_b32 v186, v186, v27, vcc
    v_cmp_eq_u32 vcc, s76, v219
    s_nop 1
    v_cndmask_b32 v209, v209, v238, vcc
    v_cndmask_b32 v187, v187, v27, vcc
    v_cmp_eq_u32 vcc, s76, v220
    s_nop 1
    v_cndmask_b32 v210, v210, v238, vcc
    v_cndmask_b32 v188, v188, v27, vcc
    v_cmp_eq_u32 vcc, s76, v221
    s_nop 1
    v_cndmask_b32 v211, v211, v238, vcc
    v_cndmask_b32 v189, v189, v27, vcc
    v_cmp_eq_u32 vcc, s76, v222
    s_nop 1
    v_cndmask_b32 v212, v212, v238, vcc
    v_cndmask_b32 v190, v190, v27, vcc
    s_branch L_fb0
    s_endpgm
.section .rodata,"a"
.p2align 6
.amdhsa_kernel sequential_preLN__gqa_block_cached__mixer_token_mlp__decode_kernel
  .amdhsa_next_free_vgpr 256
  .amdhsa_next_free_sgpr 102
  .amdhsa_accum_offset 256
  .amdhsa_group_segment_fixed_size 0
  .amdhsa_kernarg_size 104
  .amdhsa_user_sgpr_count 2
  .amdhsa_user_sgpr_kernarg_segment_ptr 1
  .amdhsa_system_sgpr_workgroup_id_x 1
  .amdhsa_float_denorm_mode_32 3
.end_amdhsa_kernel
```
